```python
import torch

def _softmax(x, axis=-1):
    return torch.softmax(x, dim=axis)
def _gelu(x):
    return torch.nn.functional.gelu(x, approximate="tanh")
def _silu(x):
    return torch.nn.functional.silu(x)
def _sigmoid(x):
    return torch.sigmoid(x)
def _layernorm(x, axis=-1, eps=1e-5):
    m = x.mean(dim=axis, keepdim=True)
    v = x.var(dim=axis, keepdim=True, unbiased=False)
    return (x - m) / torch.sqrt(v + eps)
def _scatter_add(tgt, idx, src, axis=0):
    return tgt.clone().index_add_(axis, idx, src)
def _segment_sum(src, seg, n):
    out = torch.zeros((n,) + src.shape[1:], dtype=src.dtype)
    return out.index_add_(0, seg, src)
def _pad(x, pw):
    flat = tuple(v for pair in reversed(pw) for v in pair)
    return torch.nn.functional.pad(x, flat)

kernel_name = 'parallel_sum__ssm_conv_h3__glu_gated_reglu__prompt'

def setup_inputs():

    _w = (lambda a: (lambda t: t.to(torch.bfloat16) if t.is_floating_point() else t)(torch.as_tensor(a)))
    def _A_setup():
        B, S, D = 1, 2048, 512
        ks = 4
        return {
            "q": _w((lambda *s: torch.randn(*s, dtype=torch.bfloat16) * 0.05)(B, S, D)),
            "k": _w((lambda *s: torch.randn(*s, dtype=torch.bfloat16) * 0.2)(B, S, D)),
            "v": _w((lambda *s: torch.randn(*s, dtype=torch.bfloat16) * 0.2)(B, S, D)),
            "shift_k": _w((lambda *s: torch.randn(*s, dtype=torch.bfloat16) * 0.2)(D, ks) * 0.5),
            "ssm_k": _w((lambda *s: torch.randn(*s, dtype=torch.bfloat16) * 0.4)(D, S) * (1.0 / S ** 0.5)),
            "ssm_D": _w((lambda *s: torch.randn(*s, dtype=torch.bfloat16) * 0.2)(D)),
        }
    _A_in = _A_setup()

    def _B_setup():
        B, S, D, F = 1, 2048, 512, 1792
        return {
            "x": _w((lambda *s: torch.randn(*s, dtype=torch.bfloat16) * 0.05)(B, S, D)),
            "W_gate": _w((lambda *s: torch.randn(*s, dtype=torch.bfloat16) * 0.2)(D, F) * (2.0 / D) ** 0.5),
            "W_up": _w((lambda *s: torch.randn(*s, dtype=torch.bfloat16) * 0.2)(D, F) * (2.0 / D) ** 0.5),
            "W_down": _w((lambda *s: torch.randn(*s, dtype=torch.bfloat16) * 0.2)(F, D) * (1.0 / F) ** 0.5),
        }
    _B_in = _B_setup()

    return {
        "A_q": _A_in["q"],
        "A_k": _A_in["k"],
        "A_v": _A_in["v"],
        "A_shift_k": _A_in["shift_k"],
        "A_ssm_k": _A_in["ssm_k"],
        "A_ssm_D": _A_in["ssm_D"],
        "B_x": _B_in["x"],
        "B_W_gate": _B_in["W_gate"],
        "B_W_up": _B_in["W_up"],
        "B_W_down": _B_in["W_down"],
    }

def reference(A_q, A_k, A_v, A_shift_k, A_ssm_k, A_ssm_D, B_x, B_W_gate, B_W_up, B_W_down):
    def _A_ref(q, k, v, shift_k, ssm_k, ssm_D):
        B, S, D = q.shape
        ks = shift_k.shape[-1]
        k_pad = _pad(k, ((0, 0), (ks - 1, 0), (0, 0)))
        k_shift = torch.zeros_like(k)
        for t in range(ks):
            k_shift = k_shift + k_pad[:, t:t + S, :] * shift_k[:, ks - 1 - t][None, None, :]
        kv = k_shift * v
        L = 2 * S
        kv_pad = _pad(kv, ((0, 0), (0, S), (0, 0)))
        kf_pad = _pad(ssm_k, ((0, 0), (0, S)))
        kv_f = (lambda x, axes=(-2,-1): torch.fft.rfft2(x.float(), dim=axes))(kv_pad[:, None, :, :], axes=(1, 2))
        kf_f = (lambda x, axes=(-2,-1): torch.fft.rfft2(x.float(), dim=axes))(kf_pad[:, None, :], axes=(1, 2))
        kf_f = (lambda x, *d: x.permute(*d))(kf_f, 1, 2, 0)
        y_f = kv_f * kf_f[None, :, :, :]
        y = (lambda x, s, axes=(-2,-1): torch.fft.irfft2(x, s=s, dim=axes).to(torch.bfloat16))(y_f, (1, L), axes=(1, 2))[:, 0, :S, :]
        y = y + kv * ssm_D[None, None, :]
        return q * y

    def _B_ref(x, W_gate, W_up, W_down):
        gate = torch.einsum("bsd,df->bsf", x, W_gate)
        up = torch.einsum("bsd,df->bsf", x, W_up)
        gate = gate * (lambda x, dt: x.to(dt))(gate > 0, gate.dtype)
        h = gate * up
        return torch.einsum("bsf,fd->bsd", h, W_down)

    x = A_q
    xn = _layernorm(x, axis=-1)
    return x + _A_ref(xn, A_k, A_v, A_shift_k, A_ssm_k, A_ssm_D) + _B_ref(xn, B_W_gate, B_W_up, B_W_down)
```

```asm
; @launch grid=(256,1,1) block=(256,1,1) lds=163840
.amdgcn_target "amdgcn-amd-amdhsa--gfx950"
.text
.globl parallel_sum__ssm_conv_h3__glu_gated_reglu__prompt_kernel
.p2align 8
.type parallel_sum__ssm_conv_h3__glu_gated_reglu__prompt_kernel,@function
parallel_sum__ssm_conv_h3__glu_gated_reglu__prompt_kernel:
    s_cmp_ge_u32 s2, 256
    s_cbranch_scc1 L_end
    s_load_dwordx2 s[44:45], s[0:1], 0
    s_load_dwordx4 s[24:27], s[0:1], 56
    s_load_dwordx2 s[48:49], s[0:1], 8
    s_load_dwordx2 s[52:53], s[0:1], 16
    s_load_dwordx2 s[56:57], s[0:1], 24
    s_load_dwordx2 s[76:77], s[0:1], 96
    s_load_dwordx2 s[60:61], s[0:1], 32
    s_load_dwordx2 s[30:31], s[0:1], 40
    s_load_dwordx2 s[68:69], s[0:1], 72
    s_load_dwordx2 s[72:73], s[0:1], 80
    s_getpc_b64 s[36:37]
L_pc:
    v_lshrrev_b32 v62, 5, v0
    v_lshlrev_b32 v62, 7, v62
    s_lshr_b32 s6, s2, 3
    s_lshl_b32 s6, s6, 10
    v_add_u32 v2, s6, v62
    v_min_u32 v2, L_slow0-L_pc, v2
    global_load_dword v63, v2, s[36:37]
    v_lshrrev_b32 v1, 6, v0
    v_and_b32 v0, 63, v0
    v_readfirstlane_b32 s3, v1
    s_mov_b32 s46, 2097152
    s_mov_b32 s47, 0x20000
    s_mov_b32 s66, 1835008
    s_mov_b32 s67, 0x20000
    s_mov_b32 s41, s2
    v_lshrrev_b32 v54, 3, v0
    v_and_b32 v55, 7, v0
    v_lshlrev_b32 v56, 4, v55
    v_lshl_add_u32 v56, v54, 10, v56
    v_accvgpr_write_b32 a224, v56
    s_mov_b32 s15, 0xffff0000
    v_lshlrev_b32 v32, 24, v0
    s_mul_i32 s14, s3, 24704
    s_lshl_b32 s18, s3, 13
    s_add_u32 s18, s18, 98816
    v_lshrrev_b32 v21, 4, v0
    v_xor_b32 v22, v21, v55
    v_lshlrev_b32 v22, 4, v22
    v_lshl_add_u32 v48, v54, 10, v22
    v_xor_b32 v49, 64, v48
    v_add_u32 v50, 14336, v48
    v_add_u32 v51, 21504, v49
    v_add_u32 v49, 7168, v49
    v_and_b32 v22, 15, v0
    v_lshlrev_b32 v23, 1, v21
    v_xor_b32 v22, v22, v23
    v_lshlrev_b32 v22, 4, v22
    v_mul_u32_u24 v21, 3584, v21
    v_add_u32 v5, v21, v22
    v_add_u32 v6, 13312, v5
    v_add_u32 v7, 26624, v5
    v_add_u32 v8, 39936, v5
    v_add_u32 v9, 57344, v5
    v_add_u32 v10, 70656, v5
    v_add_u32 v11, 83968, v5
    v_add_u32 v12, 97280, v5
    s_and_b32 s10, s41, 3
    s_lshl_b32 s4, s10, 2
    s_bfe_u32 s9, s41, 0x20003
    s_add_u32 s4, s4, s9
    s_lshr_b32 s8, s41, 5
    s_bfe_u32 s11, s41, 0x10002
    s_mul_i32 s5, s11, 7
    s_add_u32 s5, s5, s8
    s_and_b32 s8, s8, 3
    s_add_u32 s8, s8, 4
    s_lshl_b32 s6, s10, 1
    s_add_u32 s6, s6, s11
    s_lshl_b32 s6, s6, 2
    s_bfe_u32 s9, s41, 0x20003
    s_add_u32 s6, s6, s9
    s_lshl_b32 s17, s4, 17
    s_lshl_b32 s10, s3, 15
    s_add_u32 s17, s17, s10
    s_lshr_b32 s10, s3, 1
    s_mul_i32 s11, s10, 114688
    s_lshl_b32 s10, s5, 8
    s_add_u32 s11, s11, s10
    s_add_u32 s32, s8, 0
    s_and_b32 s32, s32, 7
    s_mul_i32 s32, s32, 229376
    s_add_u32 s32, s32, s11
    s_waitcnt lgkmcnt(0)
    s_cmp_ge_u32 s41, 224
    s_cbranch_scc1 L_skip0
    s_add_u32 s9, s8, 0
    s_and_b32 s9, s9, 7
    s_lshl_b32 s9, s9, 7
    s_add_u32 m0, s18, 0
    s_add_u32 s9, s9, s17
    buffer_load_dwordx4 v48, s[44:47], s9 offen offset:0 lds
    buffer_load_dwordx4 v49, s[44:47], s9 offen offset:1024 lds
    buffer_load_dwordx4 v50, s[44:47], s9 offen offset:2048 lds
    buffer_load_dwordx4 v51, s[44:47], s9 offen offset:3072 lds
    s_bitcmp1_b32 s3, 0
    s_cselect_b32 s64, s26, s24
    s_cselect_b32 s65, s27, s25
    s_add_u32 m0, s14, 8192
    s_nop 0
    buffer_load_dwordx4 v5, s[64:67], s32 offen offset:0 lds
    buffer_load_dwordx4 v6, s[64:67], s32 offen offset:1024 lds
    buffer_load_dwordx4 v7, s[64:67], s32 offen offset:2048 lds
    buffer_load_dwordx4 v8, s[64:67], s32 offen offset:3072 lds
    s_add_u32 m0, s14, 12288
    s_nop 0
    buffer_load_dwordx4 v9, s[64:67], s32 offen offset:0 lds
    buffer_load_dwordx4 v10, s[64:67], s32 offen offset:1024 lds
    buffer_load_dwordx4 v11, s[64:67], s32 offen offset:2048 lds
    buffer_load_dwordx4 v12, s[64:67], s32 offen offset:3072 lds
    s_branch L_skip1
L_skip0:
    s_bitcmp1_b32 s41, 3
    s_cselect_b32 s64, s26, s24
    s_cselect_b32 s65, s27, s25
    s_lshl_b32 s17, s6, 2
    s_add_u32 s17, s17, s3
    s_lshl_b32 s9, s17, 14
    s_add_u32 s10, s9, 8192
    v_accvgpr_read_b32 v22, a224
    buffer_load_dwordx4 v[64:67], v22, s[44:47], s9 offen offset:0
    buffer_load_dwordx4 v[68:71], v22, s[44:47], s9 offen offset:128
    buffer_load_dwordx4 v[72:75], v22, s[44:47], s9 offen offset:256
    buffer_load_dwordx4 v[76:79], v22, s[44:47], s9 offen offset:384
    buffer_load_dwordx4 v[80:83], v22, s[44:47], s9 offen offset:512
    buffer_load_dwordx4 v[84:87], v22, s[44:47], s9 offen offset:640
    buffer_load_dwordx4 v[88:91], v22, s[44:47], s9 offen offset:768
    buffer_load_dwordx4 v[92:95], v22, s[44:47], s9 offen offset:896
    buffer_load_dwordx4 v[96:99], v22, s[44:47], s10 offen offset:0
    buffer_load_dwordx4 v[100:103], v22, s[44:47], s10 offen offset:128
    buffer_load_dwordx4 v[104:107], v22, s[44:47], s10 offen offset:256
    buffer_load_dwordx4 v[108:111], v22, s[44:47], s10 offen offset:384
    buffer_load_dwordx4 v[112:115], v22, s[44:47], s10 offen offset:512
    buffer_load_dwordx4 v[116:119], v22, s[44:47], s10 offen offset:640
    buffer_load_dwordx4 v[120:123], v22, s[44:47], s10 offen offset:768
    buffer_load_dwordx4 v[124:127], v22, s[44:47], s10 offen offset:896
L_skip1:
    s_add_u32 s33, s8, 1
    s_and_b32 s33, s33, 7
    s_mul_i32 s33, s33, 229376
    s_add_u32 s33, s33, s11
    s_add_u32 s34, s8, 2
    s_and_b32 s34, s34, 7
    s_mul_i32 s34, s34, 229376
    s_add_u32 s34, s34, s11
    s_add_u32 s35, s8, 3
    s_and_b32 s35, s35, 7
    s_mul_i32 s35, s35, 229376
    s_add_u32 s35, s35, s11
    s_add_u32 s36, s8, 4
    s_and_b32 s36, s36, 7
    s_mul_i32 s36, s36, 229376
    s_add_u32 s36, s36, s11
    s_add_u32 s37, s8, 5
    s_and_b32 s37, s37, 7
    s_mul_i32 s37, s37, 229376
    s_add_u32 s37, s37, s11
    s_add_u32 s38, s8, 6
    s_and_b32 s38, s38, 7
    s_mul_i32 s38, s38, 229376
    s_add_u32 s38, s38, s11
    s_add_u32 s39, s8, 7
    s_and_b32 s39, s39, 7
    s_mul_i32 s39, s39, 229376
    s_add_u32 s39, s39, s11
    s_mov_b32 s50, 2097152
    s_mov_b32 s51, 0x20000
    s_mov_b32 s54, 2097152
    s_mov_b32 s55, 0x20000
    s_mov_b32 s58, 4096
    s_mov_b32 s59, 0x20000
    s_and_b32 s42, s2, 7
    s_lshl_b32 s42, s42, 2
    s_lshr_b32 s40, s2, 6
    s_add_u32 s42, s42, s40
    s_bfe_u32 s40, s2, 0x30003
    v_lshlrev_b32 v33, 4, v0
    v_and_b32 v35, 31, v0
    v_lshlrev_b32 v35, 7, v35
    s_add_u32 s11, s3, 1
    v_xor_b32 v40, s11, v55
    v_lshlrev_b32 v40, 4, v40
    v_lshl_add_u32 v40, v54, 10, v40
    v_xor_b32 v41, 64, v40
    s_lshl_b32 s19, s42, 16
    s_lshl_b32 s20, s40, 7
    s_add_u32 s19, s19, s20
    s_sub_u32 s20, s19, 8192
    v_add_u32 v42, s20, v56
    s_lshl_b32 s20, s3, 13
    s_add_u32 s19, s19, s20
    s_add_u32 s20, s19, 32768
    v_lshlrev_b32 v43, 4, v54
    s_lshl_b32 s21, s40, 9
    s_lshl_b32 s10, s3, 7
    s_add_u32 s21, s21, s10
    s_lshl_b32 s22, s11, 10
    s_add_u32 s22, s22, 134912
    s_lshl_b32 s83, s2, 1
    s_lshr_b32 s9, s3, 1
    s_add_u32 s83, s83, s9
    s_mul_i32 s83, s83, 3584
    s_lshl_b32 s84, s2, 2
    s_add_u32 s84, s84, s3
    s_lshl_b32 s9, s84, 11
    s_mul_i32 s84, s84, 1792
    v_and_b32 v21, 1920, v35
    v_min_u32 v22, 3456, v35
    s_lshl_b32 s10, s3, 4
    s_mov_b64 vcc, 0xffff
    s_lshl_b64 vcc, vcc, s10
    s_mov_b32 m0, 134912
    s_mov_b64 exec, vcc
    buffer_load_dwordx4 v42, s[48:51], 0 offen nt lds
    s_mov_b64 exec, -1
    s_mov_b32 m0, s22
    s_nop 0
    buffer_load_dwordx4 v40, s[48:51], s19 offen nt lds
    s_add_u32 m0, s22, 4096
    s_nop 0
    buffer_load_dwordx4 v41, s[48:51], s20 offen nt lds
    s_add_u32 m0, s22, 8192
    s_nop 0
    buffer_load_dwordx4 v40, s[52:55], s19 offen nt lds
    s_add_u32 m0, s22, 12288
    s_nop 0
    buffer_load_dwordx4 v41, s[52:55], s20 offen nt lds
    buffer_load_dwordx4 v[44:47], v43, s[56:59], s21 offen
    s_mov_b32 s70, 1835008
    s_mov_b32 s71, 0x20000
    v_min_u32 v23, 1664, v35
    s_mov_b64 exec, 0x3fff
    buffer_load_dword v60, v23, s[68:71], s84 offen
    s_mov_b64 exec, -1
    s_add_u32 s0, s76, 12857344
    s_addc_u32 s1, s77, 0
    s_load_dword s12, s[0:1], 0
    s_lshl_b32 s10, s2, 2
    s_add_u32 s30, s30, s10
    s_addc_u32 s31, s31, 0
    s_load_dword s13, s[30:31], 0
    s_mov_b32 s62, 2097152
    s_mov_b32 s63, 0x20000
    s_mov_b32 s70, 1835008
    s_mov_b32 s71, 0x20000
    s_mov_b32 s74, 2097152
    s_mov_b32 s75, 0x20000
    s_mov_b32 s78, 13631488
    s_mov_b32 s79, 0x20000
    v_lshrrev_b32 v22, 5, v0
    v_bfe_u32 v23, v0, 1, 3
    v_xor_b32 v22, v22, v23
    v_lshlrev_b32 v22, 4, v22
    v_add_u32 v21, s18, v35
    v_xor_b32 v23, 0, v22
    v_add_u32 v1, v21, v23
    v_xor_b32 v23, 32, v22
    v_add_u32 v2, v21, v23
    v_xor_b32 v23, 64, v22
    v_add_u32 v3, v21, v23
    v_xor_b32 v23, 96, v22
    v_add_u32 v4, v21, v23
    v_bfe_u32 v21, v0, 4, 1
    v_mul_u32_u24 v21, 24704, v21
    v_lshrrev_b32 v22, 5, v0
    v_bfe_u32 v23, v0, 2, 2
    v_lshl_add_u32 v22, v22, 3, v23
    v_lshl_add_u32 v21, v22, 8, v21
    v_and_b32 v22, 3, v0
    v_lshl_add_u32 v21, v22, 3, v21
    v_lshlrev_b32 v23, 5, v23
    v_xor_b32 v22, 0, v23
    v_add_u32 v13, v21, v22
    v_add_u32 v17, 49408, v13
    v_xor_b32 v22, 32, v23
    v_add_u32 v14, v21, v22
    v_add_u32 v18, 49408, v14
    v_xor_b32 v22, 64, v23
    v_add_u32 v15, v21, v22
    v_add_u32 v19, 49408, v15
    v_xor_b32 v22, 96, v23
    v_add_u32 v16, v21, v22
    v_add_u32 v20, 49408, v16
    s_lshr_b32 s11, s3, 1
    s_mul_i32 s11, s11, 13952
    s_lshl_b32 s10, s3, 11
    s_add_u32 s11, s11, s10
    s_add_u32 s28, s11, 99200
    s_lshl_b32 s23, s2, 13
    s_add_u32 s23, s23, s10
    s_lshl_b32 s10, s40, 18
    s_lshl_b32 s11, s3, 16
    s_add_u32 s10, s10, s11
    s_lshl_b32 s11, s42, 7
    s_sub_u32 s80, s10, s11
    s_add_u32 s80, s80, 8392576
    s_lshr_b32 s81, s10, 4
    s_add_u32 s81, s81, s11
    s_add_u32 s81, s81, 12976128
    s_lshr_b32 s85, s2, 3
    s_lshl_b32 s85, s85, 12
    s_add_u32 s85, s85, 12976128
    v_sub_u32 v21, 7, v55
    v_lshrrev_b32 v22, 5, v0
    s_lshl_b32 s10, s3, 1
    v_add_u32 v22, s10, v22
    v_and_b32 v23, 3, v54
    v_lshlrev_b32 v23, 2, v23
    v_lshl_add_u32 v23, v21, 10, v23
    v_xor_b32 v56, v22, v21
    v_lshl_add_u32 v26, v56, 4, v23
    v_add_u32 v26, 135552, v26
    v_add_u32 v56, 1, v21
    v_and_b32 v56, 7, v56
    v_xor_b32 v56, v22, v56
    v_lshl_add_u32 v24, v56, 4, v23
    v_add_u32 v24, 135936, v24
    v_add_u32 v25, 8192, v24
    v_add_u32 v27, s28, v33
    v_lshlrev_b32 v30, 4, v55
    v_lshl_add_u32 v21, v54, 12, v30
    v_accvgpr_write_b32 a225, v21
    v_lshl_add_u32 v30, v54, 13, v30
    v_bfe_u32 v21, v0, 4, 1
    v_lshlrev_b32 v21, 2, v21
    v_xor_b32 v21, v55, v21
    v_lshlrev_b32 v21, 4, v21
    v_lshl_add_u32 v36, v54, 10, v21
    v_add_u32 v37, 7168, v36
    v_and_b32 v21, 31, v0
    v_min_u32 v21, 23, v21
    v_lshrrev_b32 v22, 5, v0
    v_mul_u32_u24 v22, 4512, v22
    v_lshl_add_u32 v21, v21, 4, v22
    s_mul_i32 s10, s3, 9024
    s_add_u32 s10, s10, 98816
    v_add_u32 v21, s10, v21
    v_accvgpr_write_b32 a240, v21
    s_sub_u32 s10, s23, 8
    v_add_u32 v21, s10, v33
    s_and_b32 s10, s3, 1
    v_or_b32 v22, s10, v0
    v_cmp_eq_u32 vcc, 0, v22
    s_nop 1
    v_cndmask_b32 v21, v21, -1, vcc
    v_accvgpr_write_b32 a241, v21
    s_lshr_b32 s9, s3, 1
    s_mul_i32 s9, s9, 8448
    s_add_u32 s9, s9, 134912
    s_and_b32 s10, s3, 1
    s_lshl_b32 s11, s10, 11
    s_add_u32 s11, s11, s9
    v_add_u32 v29, s11, v33
    s_mul_i32 s11, s10, 4216
    s_add_u32 s11, s11, s9
    s_add_u32 s11, s11, 4096
    v_min_u32 v28, 14, v0
    v_lshlrev_b32 v28, 3, v28
    v_add_u32 v28, s11, v28
    v_and_b32 v21, 1, v0
    v_xor_b32 v21, 1, v21
    v_mul_u32_u24 v21, 4224, v21
    v_bfe_u32 v22, v0, 1, 3
    v_sub_u32 v22, 7, v22
    v_lshrrev_b32 v23, 4, v0
    v_add_u32 v22, v22, v23
    v_lshl_add_u32 v21, v22, 4, v21
    s_xor_b32 s11, s10, 1
    s_lshl_b32 s11, s11, 8
    s_add_u32 s11, s11, s9
    v_add_u32 v21, s11, v21
    v_accvgpr_write_b32 a244, v21
    v_sub_u32 v21, 63, v0
    v_lshlrev_b32 v21, 3, v21
    s_xor_b32 s11, s10, 1
    s_lshl_b32 s11, s11, 11
    s_add_u32 s11, s11, s9
    v_add_u32 v21, s11, v21
    v_accvgpr_write_b32 a245, v21
    v_and_b32 v21, 3, v0
    v_mul_u32_u24 v21, 4512, v21
    v_bfe_u32 v22, v0, 2, 2
    v_lshl_add_u32 v21, v22, 7, v21
    v_lshl_add_u32 v21, v23, 4, v21
    s_lshr_b32 s9, s3, 1
    s_mul_i32 s9, s9, 18048
    s_xor_b32 s11, s10, 1
    s_lshl_b32 s11, s11, 8
    s_add_u32 s9, s9, s11
    s_add_u32 s9, s9, 98816
    v_add_u32 v21, s9, v21
    v_accvgpr_write_b32 a243, v21
    v_lshrrev_b32 v21, 5, v0
    v_bfe_u32 v22, v0, 2, 2
    v_lshl_add_u32 v21, v21, 2, v22
    v_lshlrev_b32 v21, 7, v21
    v_bfe_u32 v22, v0, 3, 1
    v_lshl_add_u32 v21, v22, 6, v21
    v_bfe_u32 v22, v0, 4, 1
    v_lshl_add_u32 v21, v22, 5, v21
    v_and_b32 v22, 3, v0
    v_lshl_add_u32 v21, v22, 3, v21
    s_mul_i32 s82, s3, 7168
    s_add_u32 s82, s82, 134912
    v_add_u32 v52, s82, v21
    v_add_u32 v22, s14, v21
    v_accvgpr_write_b32 a246, v22
    v_xor_b32 v21, 64, v21
    v_add_u32 v53, s82, v21
    v_add_u32 v22, s14, v21
    v_accvgpr_write_b32 a247, v22
    v_bfe_u32 v21, v0, 2, 1
    v_and_b32 v22, 3, v0
    v_lshl_add_u32 v21, v21, 4, v22
    v_lshlrev_b32 v21, 7, v21
    v_accvgpr_write_b32 a248, v21
    v_and_b32 v21, 31, v0
    v_mul_u32_u24 v21, 272, v21
    v_lshrrev_b32 v22, 5, v0
    v_lshl_add_u32 v21, v22, 4, v21
    v_add_u32 v21, s14, v21
    v_accvgpr_write_b32 a226, v21
    s_lshl_b32 s10, s3, 3
    v_add_u32 v23, s10, v54
    v_mul_u32_u24 v21, 272, v23
    v_lshl_add_u32 v21, v55, 5, v21
    v_accvgpr_write_b32 a227, v21
    v_mul_u32_u24 v21, 144, v23
    v_lshl_add_u32 v21, v55, 4, v21
    v_add_u32 v21, 152320, v21
    v_accvgpr_write_b32 a228, v21
    v_mul_u32_u24 v21, 144, v54
    v_lshl_add_u32 v21, v55, 4, v21
    s_add_u32 s10, s14, 17408
    v_add_u32 v21, s10, v21
    v_accvgpr_write_b32 a229, v21
    v_bfe_u32 v21, v0, 2, 2
    v_mul_u32_u24 v21, 144, v21
    v_and_b32 v22, 3, v0
    v_lshl_add_u32 v21, v22, 3, v21
    v_lshrrev_b32 v22, 4, v0
    v_lshl_add_u32 v21, v22, 5, v21
    v_add_u32 v21, s10, v21
    v_accvgpr_write_b32 a230, v21
    v_mul_u32_u24 v21, 144, v0
    s_lshl_b32 s10, s3, 5
    s_add_u32 s10, s10, 152320
    v_add_u32 v21, s10, v21
    v_accvgpr_write_b32 a231, v21
    s_waitcnt lgkmcnt(0)
    s_lshr_b32 s7, s41, 5
    s_xor_b32 s7, s7, 4
    s_lshl_b32 s29, s6, 16
    s_lshl_b32 s10, s3, 13
    s_add_u32 s29, s29, s10
    s_lshr_b32 s30, s29, 6
    s_add_u32 s30, s30, 12582912
    s_lshl_b32 s10, s7, 7
    s_add_u32 s29, s29, s10
    s_mul_i32 s40, s3, 458752
    s_add_u32 s40, s40, s10
    s_lshr_b32 s87, s6, 4
    s_lshl_b32 s87, s87, 16
    s_lshl_b32 s9, s7, 13
    s_add_u32 s87, s87, s9
    s_lshl_b32 s9, s3, 11
    s_add_u32 s87, s87, s9
    s_add_u32 s87, s87, 13238272
    s_lshl_b32 s9, s4, 3
    s_lshl_b32 s10, s3, 1
    s_add_u32 s9, s9, s10
    s_lshl_b32 s9, s9, 7
    s_lshl_b32 s10, s5, 8
    s_add_u32 s10, s10, 0x4000
    v_mov_b32 v21, s9
    v_mov_b32 v22, s10
    v_and_b32 v23, 2, v0
    v_cmp_eq_u32 vcc, 0, v23
    s_nop 1
    v_cndmask_b32 v21, v22, v21, vcc
    v_and_b32 v23, 1, v0
    v_lshl_add_u32 v21, v23, 7, v21
    v_add_u32 v21, 12713984, v21
    v_accvgpr_write_b32 a242, v21
    s_lshl_b32 s9, s6, 9
    s_add_u32 s9, s9, 12713984
    v_and_b32 v23, 3, v0
    v_lshlrev_b32 v23, 7, v23
    v_add_u32 v23, s9, v23
    v_accvgpr_write_b32 a249, v23
    s_lshl_b32 s86, s6, 12
    s_mul_i32 s9, s3, 7
    s_lshr_b32 s9, s9, 1
    s_lshl_b32 s9, s9, 7
    s_add_u32 s86, s86, s9
    s_add_u32 s86, s86, 13107200
    s_lshl_b32 s9, s4, 2
    s_add_u32 s9, s9, s3
    s_mul_i32 s43, s9, 114688
    s_lshl_b32 s11, s5, 13
    s_add_u32 s43, s43, s11
    s_lshl_b32 s24, s9, 4
    s_add_u32 s24, s24, s5
    s_lshl_b32 s24, s24, 7
    s_add_u32 s24, s24, 13107200
    s_mul_i32 s25, s6, 229376
    s_mul_i32 s10, s3, 28672
    s_add_u32 s25, s25, s10
    s_add_u32 s12, s12, 1
    s_add_u32 s0, s23, 10485760
    s_and_b32 s1, s3, 1
    s_lshl_b32 s1, s1, 9
    s_lshl_b32 s10, s2, 1
    s_add_u32 s1, s1, s10
    s_lshr_b32 s10, s3, 1
    s_add_u32 s1, s1, s10
    s_lshl_b32 s1, s1, 7
    s_add_u32 s1, s1, 13238272
    v_mov_b32 v31, s12
    s_lshl_b32 s10, s13, 16
    s_and_b32 s11, s13, s15
    s_bitcmp1_b32 s3, 1
    s_cselect_b32 s13, s11, s10
    s_lshl_b32 s10, s3, 16
    s_lshl_b32 s31, s7, 18
    s_add_u32 s31, s31, s10
    s_lshl_b32 s10, s6, 7
    s_add_u32 s31, s31, s10
    s_add_u32 s31, s31, 10485760
    s_cmp_ge_u32 s41, 224
    s_cbranch_scc1 L_apath
    s_add_u32 s11, s43, 4096
    s_waitcnt vmcnt(15)
    ds_read_b128 a[96:99], v1 offset:0
    ds_read_b128 a[100:103], v2 offset:0
    ds_read_b128 a[104:107], v3 offset:0
    ds_read_b128 a[108:111], v4 offset:0
    s_waitcnt vmcnt(7) lgkmcnt(0)
    s_barrier
    ds_read_b64_tr_b16 a[0:1], v13 offset:8192
    ds_read_b64_tr_b16 a[2:3], v13 offset:9216
    ds_read_b64_tr_b16 a[4:5], v14 offset:8192
    ds_read_b64_tr_b16 a[6:7], v14 offset:9216
    ds_read_b64_tr_b16 a[8:9], v15 offset:8192
    ds_read_b64_tr_b16 a[10:11], v15 offset:9216
    ds_read_b64_tr_b16 a[12:13], v16 offset:8192
    ds_read_b64_tr_b16 a[14:15], v16 offset:9216
    ds_read_b64_tr_b16 a[16:17], v13 offset:8320
    ds_read_b64_tr_b16 a[18:19], v13 offset:9344
    ds_read_b64_tr_b16 a[20:21], v14 offset:8320
    ds_read_b64_tr_b16 a[22:23], v14 offset:9344
    ds_read_b64_tr_b16 a[24:25], v15 offset:8320
    ds_read_b64_tr_b16 a[26:27], v15 offset:9344
    ds_read_b64_tr_b16 a[28:29], v16 offset:8320
    ds_read_b64_tr_b16 a[30:31], v16 offset:9344
    s_waitcnt lgkmcnt(14)
    v_mfma_f32_32x32x16_bf16 v[128:143], a[0:3], a[96:99], 0
    ds_read_b64_tr_b16 a[32:33], v13 offset:12288
    ds_read_b64_tr_b16 a[34:35], v13 offset:13312
    ds_read_b64_tr_b16 a[36:37], v14 offset:12288
    ds_read_b64_tr_b16 a[38:39], v14 offset:13312
    s_add_u32 m0, s14, 16384
    s_nop 0
    buffer_load_dwordx4 v5, s[64:67], s33 offen offset:0 lds
    buffer_load_dwordx4 v6, s[64:67], s33 offen offset:1024 lds
    s_waitcnt lgkmcnt(14)
    v_mfma_f32_32x32x16_bf16 v[144:159], a[4:7], a[96:99], 0
    ds_read_b64_tr_b16 a[40:41], v15 offset:12288
    ds_read_b64_tr_b16 a[42:43], v15 offset:13312
    buffer_load_dwordx4 v7, s[64:67], s33 offen offset:2048 lds
    buffer_load_dwordx4 v8, s[64:67], s33 offen offset:3072 lds
    v_mfma_f32_32x32x16_bf16 v[160:175], a[8:11], a[96:99], 0
    ds_read_b64_tr_b16 a[44:45], v16 offset:12288
    ds_read_b64_tr_b16 a[46:47], v16 offset:13312
    s_add_u32 m0, s14, 20480
    s_nop 0
    buffer_load_dwordx4 v9, s[64:67], s33 offen offset:0 lds
    buffer_load_dwordx4 v10, s[64:67], s33 offen offset:1024 lds
    s_waitcnt lgkmcnt(14)
    v_mfma_f32_32x32x16_bf16 v[176:191], a[12:15], a[96:99], 0
    ds_read_b64_tr_b16 a[48:49], v13 offset:12416
    ds_read_b64_tr_b16 a[50:51], v13 offset:13440
    buffer_load_dwordx4 v11, s[64:67], s33 offen offset:2048 lds
    buffer_load_dwordx4 v12, s[64:67], s33 offen offset:3072 lds
    v_mfma_f32_32x32x16_bf16 v[192:207], a[16:19], a[96:99], 0
    ds_read_b64_tr_b16 a[52:53], v14 offset:12416
    ds_read_b64_tr_b16 a[54:55], v14 offset:13440
    s_add_u32 s9, s8, 1
    s_and_b32 s9, s9, 7
    s_lshl_b32 s9, s9, 7
    s_add_u32 m0, s18, 4096
    s_add_u32 s9, s9, s17
    buffer_load_dwordx4 v48, s[44:47], s9 offen offset:0 lds
    buffer_load_dwordx4 v49, s[44:47], s9 offen offset:1024 lds
    s_waitcnt lgkmcnt(14)
    v_mfma_f32_32x32x16_bf16 v[208:223], a[20:23], a[96:99], 0
    ds_read_b64_tr_b16 a[56:57], v15 offset:12416
    ds_read_b64_tr_b16 a[58:59], v15 offset:13440
    buffer_load_dwordx4 v50, s[44:47], s9 offen offset:2048 lds
    buffer_load_dwordx4 v51, s[44:47], s9 offen offset:3072 lds
    v_mfma_f32_32x32x16_bf16 v[224:239], a[24:27], a[96:99], 0
    ds_read_b64_tr_b16 a[60:61], v16 offset:12416
    ds_read_b64_tr_b16 a[62:63], v16 offset:13440
    s_waitcnt lgkmcnt(14)
    v_mfma_f32_32x32x16_bf16 v[240:255], a[28:31], a[96:99], 0
    ds_read_b64_tr_b16 a[64:65], v17 offset:8192
    ds_read_b64_tr_b16 a[66:67], v17 offset:9216
    ds_read_b64_tr_b16 a[68:69], v18 offset:8192
    ds_read_b64_tr_b16 a[70:71], v18 offset:9216
    v_mfma_f32_32x32x16_bf16 v[128:143], a[32:35], a[100:103], v[128:143]
    ds_read_b64_tr_b16 a[72:73], v19 offset:8192
    ds_read_b64_tr_b16 a[74:75], v19 offset:9216
    s_waitcnt lgkmcnt(15)
    v_mfma_f32_32x32x16_bf16 v[144:159], a[36:39], a[100:103], v[144:159]
    ds_read_b64_tr_b16 a[76:77], v20 offset:8192
    ds_read_b64_tr_b16 a[78:79], v20 offset:9216
    s_add_u32 s9, s8, 2
    s_and_b32 s9, s9, 7
    s_lshl_b32 s9, s9, 7
    s_add_u32 m0, s18, 0
    s_add_u32 s9, s9, s17
    buffer_load_dwordx4 v48, s[44:47], s9 offen offset:0 lds
    v_mfma_f32_32x32x16_bf16 v[160:175], a[40:43], a[100:103], v[160:175]
    ds_read_b64_tr_b16 a[80:81], v17 offset:8320
    ds_read_b64_tr_b16 a[82:83], v17 offset:9344
    s_waitcnt lgkmcnt(15)
    v_mfma_f32_32x32x16_bf16 v[176:191], a[44:47], a[100:103], v[176:191]
    ds_read_b64_tr_b16 a[84:85], v18 offset:8320
    ds_read_b64_tr_b16 a[86:87], v18 offset:9344
    buffer_load_dwordx4 v49, s[44:47], s9 offen offset:1024 lds
    v_mfma_f32_32x32x16_bf16 v[192:207], a[48:51], a[100:103], v[192:207]
    ds_read_b64_tr_b16 a[0:1], v19 offset:8320
    ds_read_b64_tr_b16 a[2:3], v19 offset:9344
    buffer_load_dwordx4 v50, s[44:47], s9 offen offset:2048 lds
    buffer_load_dwordx4 v51, s[44:47], s9 offen offset:3072 lds
    s_waitcnt lgkmcnt(15)
    v_mfma_f32_32x32x16_bf16 v[208:223], a[52:55], a[100:103], v[208:223]
    ds_read_b64_tr_b16 a[4:5], v20 offset:8320
    ds_read_b64_tr_b16 a[6:7], v20 offset:9344
    v_mfma_f32_32x32x16_bf16 v[224:239], a[56:59], a[100:103], v[224:239]
    ds_read_b64_tr_b16 a[8:9], v17 offset:12288
    ds_read_b64_tr_b16 a[10:11], v17 offset:13312
    ds_read_b64_tr_b16 a[12:13], v18 offset:12288
    ds_read_b64_tr_b16 a[14:15], v18 offset:13312
    s_waitcnt lgkmcnt(15)
    v_mfma_f32_32x32x16_bf16 v[240:255], a[60:63], a[100:103], v[240:255]
    ds_read_b64_tr_b16 a[16:17], v19 offset:12288
    ds_read_b64_tr_b16 a[18:19], v19 offset:13312
    s_add_u32 m0, s14, 0
    s_nop 0
    buffer_load_dwordx4 v5, s[64:67], s34 offen offset:0 lds
    v_mfma_f32_32x32x16_bf16 v[128:143], a[64:67], a[104:107], v[128:143]
    ds_read_b64_tr_b16 a[20:21], v20 offset:12288
    ds_read_b64_tr_b16 a[22:23], v20 offset:13312
    s_waitcnt lgkmcnt(15)
    v_mfma_f32_32x32x16_bf16 v[144:159], a[68:71], a[104:107], v[144:159]
    ds_read_b64_tr_b16 a[24:25], v17 offset:12416
    ds_read_b64_tr_b16 a[26:27], v17 offset:13440
    buffer_load_dwordx4 v6, s[64:67], s34 offen offset:1024 lds
    v_mfma_f32_32x32x16_bf16 v[160:175], a[72:75], a[104:107], v[160:175]
    ds_read_b64_tr_b16 a[28:29], v18 offset:12416
    ds_read_b64_tr_b16 a[30:31], v18 offset:13440
    s_waitcnt lgkmcnt(15)
    v_mfma_f32_32x32x16_bf16 v[176:191], a[76:79], a[104:107], v[176:191]
    ds_read_b64_tr_b16 a[32:33], v19 offset:12416
    ds_read_b64_tr_b16 a[34:35], v19 offset:13440
    buffer_load_dwordx4 v7, s[64:67], s34 offen offset:2048 lds
    v_mfma_f32_32x32x16_bf16 v[192:207], a[80:83], a[104:107], v[192:207]
    ds_read_b64_tr_b16 a[36:37], v20 offset:12416
    ds_read_b64_tr_b16 a[38:39], v20 offset:13440
    s_waitcnt lgkmcnt(15)
    v_mfma_f32_32x32x16_bf16 v[208:223], a[84:87], a[104:107], v[208:223]
    buffer_load_dwordx4 v8, s[64:67], s34 offen offset:3072 lds
    v_mfma_f32_32x32x16_bf16 v[224:239], a[0:3], a[104:107], v[224:239]
    s_waitcnt lgkmcnt(14)
    v_mfma_f32_32x32x16_bf16 v[240:255], a[4:7], a[104:107], v[240:255]
    s_add_u32 m0, s14, 4096
    s_nop 0
    buffer_load_dwordx4 v9, s[64:67], s34 offen offset:0 lds
    buffer_load_dwordx4 v10, s[64:67], s34 offen offset:1024 lds
    buffer_load_dwordx4 v11, s[64:67], s34 offen offset:2048 lds
    buffer_load_dwordx4 v12, s[64:67], s34 offen offset:3072 lds
    v_mfma_f32_32x32x16_bf16 v[128:143], a[8:11], a[108:111], v[128:143]
    s_waitcnt vmcnt(16) lgkmcnt(0)
    s_barrier
    ds_read_b64_tr_b16 a[40:41], v13 offset:16384
    ds_read_b64_tr_b16 a[42:43], v13 offset:17408
    ds_read_b64_tr_b16 a[44:45], v14 offset:16384
    ds_read_b64_tr_b16 a[46:47], v14 offset:17408
    v_mfma_f32_32x32x16_bf16 v[144:159], a[12:15], a[108:111], v[144:159]
    ds_read_b64_tr_b16 a[48:49], v15 offset:16384
    ds_read_b64_tr_b16 a[50:51], v15 offset:17408
    s_waitcnt vmcnt(12)
    ds_read_b128 a[112:115], v1 offset:4096
    ds_read_b128 a[116:119], v2 offset:4096
    ds_read_b128 a[120:123], v3 offset:4096
    ds_read_b128 a[124:127], v4 offset:4096
    v_mfma_f32_32x32x16_bf16 v[160:175], a[16:19], a[108:111], v[160:175]
    ds_read_b64_tr_b16 a[52:53], v16 offset:16384
    ds_read_b64_tr_b16 a[54:55], v16 offset:17408
    ds_read2_b32 v[64:65], v26 offset0:0 offset1:32
    ds_read_b32 v66, v26 offset:256
    ds_read2_b32 v[68:69], v24 offset0:0 offset1:32
    v_mfma_f32_32x32x16_bf16 v[176:191], a[20:23], a[108:111], v[176:191]
    ds_read_b64_tr_b16 a[56:57], v13 offset:16512
    ds_read_b64_tr_b16 a[58:59], v13 offset:17536
    v_min_u32 v23, 3456, v35
    buffer_load_dword v22, v23, s[64:67], s83 offen
    ds_read2_b32 v[70:71], v24 offset0:64 offset1:96
    ds_read2_b32 v[72:73], v24 offset0:128 offset1:160
    v_mfma_f32_32x32x16_bf16 v[192:207], a[24:27], a[108:111], v[192:207]
    ds_read_b64_tr_b16 a[60:61], v14 offset:16512
    ds_read_b64_tr_b16 a[62:63], v14 offset:17536
    ds_read2_b32 v[74:75], v24 offset0:192 offset1:224
    ds_read2_b32 v[80:81], v25 offset0:0 offset1:32
    ds_read2_b32 v[82:83], v25 offset0:64 offset1:96
    v_mfma_f32_32x32x16_bf16 v[208:223], a[28:31], a[108:111], v[208:223]
    ds_read_b64_tr_b16 a[64:65], v15 offset:16512
    ds_read_b64_tr_b16 a[66:67], v15 offset:17536
    ds_read2_b32 v[84:85], v25 offset0:128 offset1:160
    ds_read2_b32 v[86:87], v25 offset0:192 offset1:224
    v_lshlrev_b32 v110, 16, v44
    v_and_b32 v112, s15, v44
    v_mfma_f32_32x32x16_bf16 v[224:239], a[32:35], a[108:111], v[224:239]
    ds_read_b64_tr_b16 a[68:69], v16 offset:16512
    ds_read_b64_tr_b16 a[70:71], v16 offset:17536
    v_lshlrev_b32 v114, 16, v45
    v_and_b32 v116, s15, v45
    v_lshlrev_b32 v111, 16, v46
    v_mfma_f32_32x32x16_bf16 v[240:255], a[36:39], a[108:111], v[240:255]
    ds_read_b64_tr_b16 a[72:73], v13 offset:20480
    ds_read_b64_tr_b16 a[74:75], v13 offset:21504
    ds_read_b64_tr_b16 a[76:77], v14 offset:20480
    ds_read_b64_tr_b16 a[78:79], v14 offset:21504
    v_and_b32 v113, s15, v46
    v_lshlrev_b32 v115, 16, v47
    s_waitcnt lgkmcnt(15)
    v_mfma_f32_32x32x16_bf16 v[128:143], a[40:43], a[112:115], v[128:143]
    ds_read_b64_tr_b16 a[80:81], v15 offset:20480
    ds_read_b64_tr_b16 a[82:83], v15 offset:21504
    v_and_b32 v117, s15, v47
    v_lshlrev_b32 v88, 16, v64
    v_and_b32 v89, s15, v64
    v_mfma_f32_32x32x16_bf16 v[144:159], a[44:47], a[112:115], v[144:159]
    ds_read_b64_tr_b16 a[84:85], v16 offset:20480
    ds_read_b64_tr_b16 a[86:87], v16 offset:21504
    s_add_u32 s9, s8, 3
    s_and_b32 s9, s9, 7
    s_lshl_b32 s9, s9, 7
    s_add_u32 m0, s18, 4096
    s_add_u32 s9, s9, s17
    buffer_load_dwordx4 v48, s[44:47], s9 offen offset:0 lds
    v_mfma_f32_32x32x16_bf16 v[160:175], a[48:51], a[112:115], v[160:175]
    ds_read_b64_tr_b16 a[0:1], v13 offset:20608
    ds_read_b64_tr_b16 a[2:3], v13 offset:21632
    buffer_load_dwordx4 v49, s[44:47], s9 offen offset:1024 lds
    buffer_load_dwordx4 v50, s[44:47], s9 offen offset:2048 lds
    buffer_load_dwordx4 v51, s[44:47], s9 offen offset:3072 lds
    v_mfma_f32_32x32x16_bf16 v[176:191], a[52:55], a[112:115], v[176:191]
    ds_read_b64_tr_b16 a[4:5], v14 offset:20608
    ds_read_b64_tr_b16 a[6:7], v14 offset:21632
    v_lshlrev_b32 v90, 16, v65
    v_and_b32 v91, s15, v65
    v_lshlrev_b32 v92, 16, v66
    v_and_b32 v93, s15, v66
    v_mfma_f32_32x32x16_bf16 v[192:207], a[56:59], a[112:115], v[192:207]
    ds_read_b64_tr_b16 a[8:9], v15 offset:20608
    ds_read_b64_tr_b16 a[10:11], v15 offset:21632
    s_add_u32 m0, s14, 8192
    s_nop 0
    buffer_load_dwordx4 v5, s[64:67], s35 offen offset:0 lds
    v_lshlrev_b32 v94, 16, v68
    s_waitcnt lgkmcnt(15)
    v_mfma_f32_32x32x16_bf16 v[208:223], a[60:63], a[112:115], v[208:223]
    ds_read_b64_tr_b16 a[12:13], v16 offset:20608
    ds_read_b64_tr_b16 a[14:15], v16 offset:21632
    v_and_b32 v95, s15, v68
    v_lshlrev_b32 v96, 16, v69
    v_and_b32 v97, s15, v69
    v_lshlrev_b32 v98, 16, v70
    v_mfma_f32_32x32x16_bf16 v[224:239], a[64:67], a[112:115], v[224:239]
    ds_read_b64_tr_b16 a[16:17], v17 offset:16384
    ds_read_b64_tr_b16 a[18:19], v17 offset:17408
    ds_read_b64_tr_b16 a[20:21], v18 offset:16384
    ds_read_b64_tr_b16 a[22:23], v18 offset:17408
    buffer_load_dwordx4 v6, s[64:67], s35 offen offset:1024 lds
    s_waitcnt lgkmcnt(15)
    v_mfma_f32_32x32x16_bf16 v[240:255], a[68:71], a[112:115], v[240:255]
    ds_read_b64_tr_b16 a[24:25], v19 offset:16384
    ds_read_b64_tr_b16 a[26:27], v19 offset:17408
    v_and_b32 v99, s15, v70
    v_lshlrev_b32 v100, 16, v71
    v_and_b32 v101, s15, v71
    v_lshlrev_b32 v102, 16, v72
    v_mfma_f32_32x32x16_bf16 v[128:143], a[72:75], a[116:119], v[128:143]
    ds_read_b64_tr_b16 a[28:29], v20 offset:16384
    ds_read_b64_tr_b16 a[30:31], v20 offset:17408
    buffer_load_dwordx4 v7, s[64:67], s35 offen offset:2048 lds
    v_and_b32 v103, s15, v72
    v_lshlrev_b32 v104, 16, v73
    s_waitcnt lgkmcnt(15)
    v_mfma_f32_32x32x16_bf16 v[144:159], a[76:79], a[116:119], v[144:159]
    ds_read_b64_tr_b16 a[32:33], v17 offset:16512
    ds_read_b64_tr_b16 a[34:35], v17 offset:17536
    v_and_b32 v105, s15, v73
    v_lshlrev_b32 v106, 16, v74
    v_and_b32 v107, s15, v74
    v_lshlrev_b32 v108, 16, v75
    v_mfma_f32_32x32x16_bf16 v[160:175], a[80:83], a[116:119], v[160:175]
    ds_read_b64_tr_b16 a[36:37], v18 offset:16512
    ds_read_b64_tr_b16 a[38:39], v18 offset:17536
    buffer_load_dwordx4 v8, s[64:67], s35 offen offset:3072 lds
    v_and_b32 v109, s15, v75
    v_mul_f32 v64, v94, v110
    s_waitcnt lgkmcnt(15)
    v_mfma_f32_32x32x16_bf16 v[176:191], a[84:87], a[116:119], v[176:191]
    ds_read_b64_tr_b16 a[40:41], v19 offset:16512
    ds_read_b64_tr_b16 a[42:43], v19 offset:17536
    v_mul_f32 v65, v95, v111
    v_mul_f32 v66, v96, v110
    v_mul_f32 v67, v97, v111
    v_mul_f32 v68, v98, v110
    v_mfma_f32_32x32x16_bf16 v[192:207], a[0:3], a[116:119], v[192:207]
    ds_read_b64_tr_b16 a[44:45], v20 offset:16512
    ds_read_b64_tr_b16 a[46:47], v20 offset:17536
    s_add_u32 m0, s14, 12288
    s_nop 0
    buffer_load_dwordx4 v9, s[64:67], s35 offen offset:0 lds
    v_mul_f32 v69, v99, v111
    s_waitcnt lgkmcnt(15)
    v_mfma_f32_32x32x16_bf16 v[208:223], a[4:7], a[116:119], v[208:223]
    ds_read_b64_tr_b16 a[48:49], v17 offset:20480
    ds_read_b64_tr_b16 a[50:51], v17 offset:21504
    ds_read_b64_tr_b16 a[52:53], v18 offset:20480
    ds_read_b64_tr_b16 a[54:55], v18 offset:21504
    v_mul_f32 v70, v100, v110
    v_mul_f32 v71, v101, v111
    v_mfma_f32_32x32x16_bf16 v[224:239], a[8:11], a[116:119], v[224:239]
    ds_read_b64_tr_b16 a[56:57], v19 offset:20480
    ds_read_b64_tr_b16 a[58:59], v19 offset:21504
    buffer_load_dwordx4 v10, s[64:67], s35 offen offset:1024 lds
    v_mul_f32 v72, v102, v110
    v_mul_f32 v73, v103, v111
    s_waitcnt lgkmcnt(15)
    v_mfma_f32_32x32x16_bf16 v[240:255], a[12:15], a[116:119], v[240:255]
    ds_read_b64_tr_b16 a[60:61], v20 offset:20480
    ds_read_b64_tr_b16 a[62:63], v20 offset:21504
    v_mul_f32 v74, v104, v110
    v_mul_f32 v75, v105, v111
    v_mul_f32 v76, v106, v110
    v_mul_f32 v77, v107, v111
    v_mfma_f32_32x32x16_bf16 v[128:143], a[16:19], a[120:123], v[128:143]
    ds_read_b64_tr_b16 a[64:65], v17 offset:20608
    ds_read_b64_tr_b16 a[66:67], v17 offset:21632
    buffer_load_dwordx4 v11, s[64:67], s35 offen offset:2048 lds
    buffer_load_dwordx4 v12, s[64:67], s35 offen offset:3072 lds
    v_mul_f32 v78, v108, v110
    v_mfma_f32_32x32x16_bf16 v[144:159], a[20:23], a[120:123], v[144:159]
    ds_read_b64_tr_b16 a[68:69], v18 offset:20608
    ds_read_b64_tr_b16 a[70:71], v18 offset:21632
    s_waitcnt vmcnt(21)
    ds_read_b128 a[128:131], v1 offset:0
    ds_read_b128 a[132:135], v2 offset:0
    ds_read_b128 a[136:139], v3 offset:0
    ds_read_b128 a[140:143], v4 offset:0
    v_mfma_f32_32x32x16_bf16 v[160:175], a[24:27], a[120:123], v[160:175]
    ds_read_b64_tr_b16 a[72:73], v19 offset:20608
    ds_read_b64_tr_b16 a[74:75], v19 offset:21632
    v_mul_f32 v79, v109, v111
    v_fmac_f32 v64, v92, v112
    v_fmac_f32 v65, v93, v113
    s_waitcnt lgkmcnt(15)
    v_mfma_f32_32x32x16_bf16 v[176:191], a[28:31], a[120:123], v[176:191]
    ds_read_b64_tr_b16 a[76:77], v20 offset:20608
    ds_read_b64_tr_b16 a[78:79], v20 offset:21632
    s_waitcnt lgkmcnt(4)
    s_add_u32 s9, s8, 4
    s_and_b32 s9, s9, 7
    s_lshl_b32 s9, s9, 7
    s_add_u32 m0, s18, 0
    s_add_u32 s9, s9, s17
    buffer_load_dwordx4 v48, s[44:47], s9 offen offset:0 lds
    v_mfma_f32_32x32x16_bf16 v[192:207], a[32:35], a[120:123], v[192:207]
    v_fmac_f32 v66, v94, v112
    v_fmac_f32 v67, v95, v113
    v_fmac_f32 v68, v96, v112
    v_fmac_f32 v69, v97, v113
    v_fmac_f32 v70, v98, v112
    v_mfma_f32_32x32x16_bf16 v[208:223], a[36:39], a[120:123], v[208:223]
    buffer_load_dwordx4 v49, s[44:47], s9 offen offset:1024 lds
    v_fmac_f32 v71, v99, v113
    v_fmac_f32 v72, v100, v112
    v_fmac_f32 v73, v101, v113
    v_fmac_f32 v74, v102, v112
    v_fmac_f32 v75, v103, v113
    v_mfma_f32_32x32x16_bf16 v[224:239], a[40:43], a[120:123], v[224:239]
    v_fmac_f32 v76, v104, v112
    v_fmac_f32 v77, v105, v113
    v_fmac_f32 v78, v106, v112
    v_fmac_f32 v79, v107, v113
    v_fmac_f32 v64, v90, v114
    v_mfma_f32_32x32x16_bf16 v[240:255], a[44:47], a[120:123], v[240:255]
    buffer_load_dwordx4 v50, s[44:47], s9 offen offset:2048 lds
    v_fmac_f32 v65, v91, v115
    v_fmac_f32 v66, v92, v114
    v_fmac_f32 v67, v93, v115
    v_fmac_f32 v68, v94, v114
    v_fmac_f32 v69, v95, v115
    v_mfma_f32_32x32x16_bf16 v[128:143], a[48:51], a[124:127], v[128:143]
    s_waitcnt vmcnt(16) lgkmcnt(0)
    s_barrier
    ds_read_b64_tr_b16 a[80:81], v13 offset:0
    ds_read_b64_tr_b16 a[82:83], v13 offset:1024
    ds_read_b64_tr_b16 a[84:85], v14 offset:0
    ds_read_b64_tr_b16 a[86:87], v14 offset:1024
    buffer_load_dwordx4 v51, s[44:47], s9 offen offset:3072 lds
    v_mfma_f32_32x32x16_bf16 v[144:159], a[52:55], a[124:127], v[144:159]
    ds_read_b64_tr_b16 a[0:1], v15 offset:0
    ds_read_b64_tr_b16 a[2:3], v15 offset:1024
    v_fmac_f32 v70, v96, v114
    v_fmac_f32 v71, v97, v115
    v_fmac_f32 v72, v98, v114
    v_fmac_f32 v73, v99, v115
    v_mfma_f32_32x32x16_bf16 v[160:175], a[56:59], a[124:127], v[160:175]
    ds_read_b64_tr_b16 a[4:5], v16 offset:0
    ds_read_b64_tr_b16 a[6:7], v16 offset:1024
    s_add_u32 m0, s14, 16384
    s_nop 0
    buffer_load_dwordx4 v5, s[64:67], s36 offen offset:0 lds
    v_fmac_f32 v74, v100, v114
    v_mfma_f32_32x32x16_bf16 v[176:191], a[60:63], a[124:127], v[176:191]
    ds_read_b64_tr_b16 a[8:9], v13 offset:128
    ds_read_b64_tr_b16 a[10:11], v13 offset:1152
    v_fmac_f32 v75, v101, v115
    v_fmac_f32 v76, v102, v114
    v_fmac_f32 v77, v103, v115
    v_fmac_f32 v78, v104, v114
    v_mfma_f32_32x32x16_bf16 v[192:207], a[64:67], a[124:127], v[192:207]
    ds_read_b64_tr_b16 a[12:13], v14 offset:128
    ds_read_b64_tr_b16 a[14:15], v14 offset:1152
    buffer_load_dwordx4 v6, s[64:67], s36 offen offset:1024 lds
    v_fmac_f32 v79, v105, v115
    v_fmac_f32 v64, v88, v116
    v_mfma_f32_32x32x16_bf16 v[208:223], a[68:71], a[124:127], v[208:223]
    ds_read_b64_tr_b16 a[16:17], v15 offset:128
    ds_read_b64_tr_b16 a[18:19], v15 offset:1152
    v_fmac_f32 v65, v89, v117
    v_fmac_f32 v66, v90, v116
    v_fmac_f32 v67, v91, v117
    v_fmac_f32 v68, v92, v116
    v_mfma_f32_32x32x16_bf16 v[224:239], a[72:75], a[124:127], v[224:239]
    ds_read_b64_tr_b16 a[20:21], v16 offset:128
    ds_read_b64_tr_b16 a[22:23], v16 offset:1152
    buffer_load_dwordx4 v7, s[64:67], s36 offen offset:2048 lds
    v_fmac_f32 v69, v93, v117
    v_fmac_f32 v70, v94, v116
    v_mfma_f32_32x32x16_bf16 v[240:255], a[76:79], a[124:127], v[240:255]
    ds_read_b64_tr_b16 a[24:25], v13 offset:4096
    ds_read_b64_tr_b16 a[26:27], v13 offset:5120
    ds_read_b64_tr_b16 a[28:29], v14 offset:4096
    ds_read_b64_tr_b16 a[30:31], v14 offset:5120
    v_fmac_f32 v71, v95, v117
    v_fmac_f32 v72, v96, v116
    s_waitcnt lgkmcnt(15)
    v_mfma_f32_32x32x16_bf16 v[128:143], a[80:83], a[128:131], v[128:143]
    ds_read_b64_tr_b16 a[32:33], v15 offset:4096
    ds_read_b64_tr_b16 a[34:35], v15 offset:5120
    buffer_load_dwordx4 v8, s[64:67], s36 offen offset:3072 lds
    v_fmac_f32 v73, v97, v117
    v_fmac_f32 v74, v98, v116
    s_waitcnt lgkmcnt(15)
    v_mfma_f32_32x32x16_bf16 v[144:159], a[84:87], a[128:131], v[144:159]
    ds_read_b64_tr_b16 a[36:37], v16 offset:4096
    ds_read_b64_tr_b16 a[38:39], v16 offset:5120
    v_fmac_f32 v75, v99, v117
    v_fmac_f32 v76, v100, v116
    v_fmac_f32 v77, v101, v117
    v_fmac_f32 v78, v102, v116
    v_mfma_f32_32x32x16_bf16 v[160:175], a[0:3], a[128:131], v[160:175]
    ds_read_b64_tr_b16 a[40:41], v13 offset:4224
    ds_read_b64_tr_b16 a[42:43], v13 offset:5248
    s_add_u32 m0, s14, 20480
    s_nop 0
    buffer_load_dwordx4 v9, s[64:67], s36 offen offset:0 lds
    v_fmac_f32 v79, v103, v117
    s_waitcnt lgkmcnt(15)
    v_mfma_f32_32x32x16_bf16 v[176:191], a[4:7], a[128:131], v[176:191]
    ds_read_b64_tr_b16 a[44:45], v14 offset:4224
    ds_read_b64_tr_b16 a[46:47], v14 offset:5248
    v_lshlrev_b32 v88, 16, v80
    v_and_b32 v89, s15, v80
    v_lshlrev_b32 v90, 16, v81
    v_and_b32 v91, s15, v81
    v_mfma_f32_32x32x16_bf16 v[192:207], a[8:11], a[128:131], v[192:207]
    ds_read_b64_tr_b16 a[48:49], v15 offset:4224
    ds_read_b64_tr_b16 a[50:51], v15 offset:5248
    buffer_load_dwordx4 v10, s[64:67], s36 offen offset:1024 lds
    v_lshlrev_b32 v92, 16, v82
    v_and_b32 v93, s15, v82
    s_waitcnt lgkmcnt(15)
    v_mfma_f32_32x32x16_bf16 v[208:223], a[12:15], a[128:131], v[208:223]
    ds_read_b64_tr_b16 a[52:53], v16 offset:4224
    ds_read_b64_tr_b16 a[54:55], v16 offset:5248
    v_lshlrev_b32 v94, 16, v83
    v_and_b32 v95, s15, v83
    v_lshlrev_b32 v96, 16, v84
    v_and_b32 v97, s15, v84
    v_mfma_f32_32x32x16_bf16 v[224:239], a[16:19], a[128:131], v[224:239]
    ds_read_b64_tr_b16 a[56:57], v17 offset:0
    ds_read_b64_tr_b16 a[58:59], v17 offset:1024
    ds_read_b64_tr_b16 a[60:61], v18 offset:0
    ds_read_b64_tr_b16 a[62:63], v18 offset:1024
    buffer_load_dwordx4 v11, s[64:67], s36 offen offset:2048 lds
    s_waitcnt lgkmcnt(15)
    v_mfma_f32_32x32x16_bf16 v[240:255], a[20:23], a[128:131], v[240:255]
    ds_read_b64_tr_b16 a[64:65], v19 offset:0
    ds_read_b64_tr_b16 a[66:67], v19 offset:1024
    v_lshlrev_b32 v98, 16, v85
    v_and_b32 v99, s15, v85
    v_lshlrev_b32 v100, 16, v86
    v_and_b32 v101, s15, v86
    v_mfma_f32_32x32x16_bf16 v[128:143], a[24:27], a[132:135], v[128:143]
    ds_read_b64_tr_b16 a[68:69], v20 offset:0
    ds_read_b64_tr_b16 a[70:71], v20 offset:1024
    buffer_load_dwordx4 v12, s[64:67], s36 offen offset:3072 lds
    v_lshlrev_b32 v102, 16, v87
    v_and_b32 v103, s15, v87
    s_waitcnt lgkmcnt(15)
    v_mfma_f32_32x32x16_bf16 v[144:159], a[28:31], a[132:135], v[144:159]
    ds_read_b64_tr_b16 a[72:73], v17 offset:128
    ds_read_b64_tr_b16 a[74:75], v17 offset:1152
    v_mul_f32 v64, v64, v88
    v_mul_f32 v65, v65, v89
    v_mul_f32 v66, v66, v90
    v_mul_f32 v67, v67, v91
    v_mfma_f32_32x32x16_bf16 v[160:175], a[32:35], a[132:135], v[160:175]
    ds_read_b64_tr_b16 a[76:77], v18 offset:128
    ds_read_b64_tr_b16 a[78:79], v18 offset:1152
    s_waitcnt vmcnt(20)
    ds_read_b128 a[144:147], v1 offset:4096
    ds_read_b128 a[148:151], v2 offset:4096
    ds_read_b128 a[152:155], v3 offset:4096
    ds_read_b128 a[156:159], v4 offset:4096
    s_waitcnt lgkmcnt(15)
    v_mfma_f32_32x32x16_bf16 v[176:191], a[36:39], a[132:135], v[176:191]
    ds_read_b64_tr_b16 a[80:81], v19 offset:128
    ds_read_b64_tr_b16 a[82:83], v19 offset:1152
    v_mul_f32 v68, v68, v92
    v_mul_f32 v69, v69, v93
    v_mul_f32 v70, v70, v94
    v_mul_f32 v71, v71, v95
    v_mfma_f32_32x32x16_bf16 v[192:207], a[40:43], a[132:135], v[192:207]
    ds_read_b64_tr_b16 a[84:85], v20 offset:128
    ds_read_b64_tr_b16 a[86:87], v20 offset:1152
    v_mul_f32 v72, v72, v96
    v_mul_f32 v73, v73, v97
    v_mul_f32 v74, v74, v98
    v_mfma_f32_32x32x16_bf16 v[208:223], a[44:47], a[132:135], v[208:223]
    ds_read_b64_tr_b16 a[0:1], v17 offset:4096
    ds_read_b64_tr_b16 a[2:3], v17 offset:5120
    ds_read_b64_tr_b16 a[4:5], v18 offset:4096
    ds_read_b64_tr_b16 a[6:7], v18 offset:5120
    v_mul_f32 v75, v75, v99
    v_mul_f32 v76, v76, v100
    v_mfma_f32_32x32x16_bf16 v[224:239], a[48:51], a[132:135], v[224:239]
    ds_read_b64_tr_b16 a[8:9], v19 offset:4096
    ds_read_b64_tr_b16 a[10:11], v19 offset:5120
    v_mul_f32 v77, v77, v101
    v_mul_f32 v78, v78, v102
    v_mul_f32 v79, v79, v103
    s_waitcnt lgkmcnt(15)
    v_mfma_f32_32x32x16_bf16 v[240:255], a[52:55], a[132:135], v[240:255]
    ds_read_b64_tr_b16 a[12:13], v20 offset:4096
    ds_read_b64_tr_b16 a[14:15], v20 offset:5120
    s_waitcnt lgkmcnt(12)
    s_add_u32 s9, s8, 5
    s_and_b32 s9, s9, 7
    s_lshl_b32 s9, s9, 7
    s_add_u32 m0, s18, 4096
    s_add_u32 s9, s9, s17
    buffer_load_dwordx4 v48, s[44:47], s9 offen offset:0 lds
    v_mfma_f32_32x32x16_bf16 v[128:143], a[56:59], a[136:139], v[128:143]
    ds_read_b64_tr_b16 a[16:17], v17 offset:4224
    ds_read_b64_tr_b16 a[18:19], v17 offset:5248
    v_cvt_pk_bf16_f32 v40, v78, v76
    v_cvt_pk_bf16_f32 v41, v74, v72
    v_cvt_pk_bf16_f32 v42, v70, v68
    v_mfma_f32_32x32x16_bf16 v[144:159], a[60:63], a[136:139], v[144:159]
    ds_read_b64_tr_b16 a[20:21], v18 offset:4224
    ds_read_b64_tr_b16 a[22:23], v18 offset:5248
    buffer_load_dwordx4 v49, s[44:47], s9 offen offset:1024 lds
    v_cvt_pk_bf16_f32 v43, v66, v64
    v_cvt_pk_bf16_f32 v44, v79, v77
    v_cvt_pk_bf16_f32 v45, v75, v73
    v_mfma_f32_32x32x16_bf16 v[160:175], a[64:67], a[136:139], v[160:175]
    ds_read_b64_tr_b16 a[24:25], v19 offset:4224
    ds_read_b64_tr_b16 a[26:27], v19 offset:5248
    buffer_load_dwordx4 v50, s[44:47], s9 offen offset:2048 lds
    buffer_load_dwordx4 v51, s[44:47], s9 offen offset:3072 lds
    v_cvt_pk_bf16_f32 v46, v71, v69
    v_cvt_pk_bf16_f32 v47, v67, v65
    v_mfma_f32_32x32x16_bf16 v[176:191], a[68:71], a[136:139], v[176:191]
    ds_read_b64_tr_b16 a[28:29], v20 offset:4224
    ds_read_b64_tr_b16 a[30:31], v20 offset:5248
    v_mfma_f32_32x32x16_bf16 v[192:207], a[72:75], a[136:139], v[192:207]
    buffer_store_dwordx4 v[40:43], v30, s[76:79], s80 offen sc1
    s_waitcnt lgkmcnt(15)
    v_mfma_f32_32x32x16_bf16 v[208:223], a[76:79], a[136:139], v[208:223]
    s_add_u32 s80, s80, 4096
    buffer_store_dwordx4 v[44:47], v30, s[76:79], s80 offen sc1
    v_mfma_f32_32x32x16_bf16 v[224:239], a[80:83], a[136:139], v[224:239]
    s_waitcnt lgkmcnt(14)
    v_mfma_f32_32x32x16_bf16 v[240:255], a[84:87], a[136:139], v[240:255]
    v_mfma_f32_32x32x16_bf16 v[128:143], a[0:3], a[140:143], v[128:143]
    s_waitcnt vmcnt(18) lgkmcnt(0)
    s_barrier
    ds_read_b64_tr_b16 a[32:33], v13 offset:8192
    ds_read_b64_tr_b16 a[34:35], v13 offset:9216
    ds_read_b64_tr_b16 a[36:37], v14 offset:8192
    ds_read_b64_tr_b16 a[38:39], v14 offset:9216
    v_mfma_f32_32x32x16_bf16 v[144:159], a[4:7], a[140:143], v[144:159]
    ds_read_b64_tr_b16 a[40:41], v15 offset:8192
    ds_read_b64_tr_b16 a[42:43], v15 offset:9216
    v_mfma_f32_32x32x16_bf16 v[160:175], a[8:11], a[140:143], v[160:175]
    ds_read_b64_tr_b16 a[44:45], v16 offset:8192
    ds_read_b64_tr_b16 a[46:47], v16 offset:9216
    v_mfma_f32_32x32x16_bf16 v[176:191], a[12:15], a[140:143], v[176:191]
    ds_read_b64_tr_b16 a[48:49], v13 offset:8320
    ds_read_b64_tr_b16 a[50:51], v13 offset:9344
    v_mfma_f32_32x32x16_bf16 v[192:207], a[16:19], a[140:143], v[192:207]
    ds_read_b64_tr_b16 a[52:53], v14 offset:8320
    ds_read_b64_tr_b16 a[54:55], v14 offset:9344
    s_waitcnt vmcnt(14)
    ds_read_b128 a[160:163], v1 offset:0
    ds_read_b128 a[164:167], v2 offset:0
    ds_read_b128 a[168:171], v3 offset:0
    ds_read_b128 a[172:175], v4 offset:0
    v_mfma_f32_32x32x16_bf16 v[208:223], a[20:23], a[140:143], v[208:223]
    ds_read_b64_tr_b16 a[56:57], v15 offset:8320
    ds_read_b64_tr_b16 a[58:59], v15 offset:9344
    v_mfma_f32_32x32x16_bf16 v[224:239], a[24:27], a[140:143], v[224:239]
    ds_read_b64_tr_b16 a[60:61], v16 offset:8320
    ds_read_b64_tr_b16 a[62:63], v16 offset:9344
    v_mfma_f32_32x32x16_bf16 v[240:255], a[28:31], a[140:143], v[240:255]
    ds_read_b64_tr_b16 a[64:65], v13 offset:12288
    ds_read_b64_tr_b16 a[66:67], v13 offset:13312
    ds_read_b64_tr_b16 a[68:69], v14 offset:12288
    ds_read_b64_tr_b16 a[70:71], v14 offset:13312
    s_waitcnt lgkmcnt(15)
    v_mfma_f32_32x32x16_bf16 v[128:143], a[32:35], a[144:147], v[128:143]
    ds_read_b64_tr_b16 a[72:73], v15 offset:12288
    ds_read_b64_tr_b16 a[74:75], v15 offset:13312
    v_mfma_f32_32x32x16_bf16 v[144:159], a[36:39], a[144:147], v[144:159]
    ds_read_b64_tr_b16 a[76:77], v16 offset:12288
    ds_read_b64_tr_b16 a[78:79], v16 offset:13312
    s_waitcnt lgkmcnt(12)
    s_add_u32 s9, s8, 6
    s_and_b32 s9, s9, 7
    s_lshl_b32 s9, s9, 7
    s_add_u32 m0, s18, 0
    s_add_u32 s9, s9, s17
    buffer_load_dwordx4 v48, s[44:47], s9 offen offset:0 lds
    v_mfma_f32_32x32x16_bf16 v[160:175], a[40:43], a[144:147], v[160:175]
    ds_read_b64_tr_b16 a[80:81], v13 offset:12416
    ds_read_b64_tr_b16 a[82:83], v13 offset:13440
    v_mfma_f32_32x32x16_bf16 v[176:191], a[44:47], a[144:147], v[176:191]
    ds_read_b64_tr_b16 a[84:85], v14 offset:12416
    ds_read_b64_tr_b16 a[86:87], v14 offset:13440
    buffer_load_dwordx4 v49, s[44:47], s9 offen offset:1024 lds
    v_mfma_f32_32x32x16_bf16 v[192:207], a[48:51], a[144:147], v[192:207]
    ds_read_b64_tr_b16 a[0:1], v15 offset:12416
    ds_read_b64_tr_b16 a[2:3], v15 offset:13440
    s_waitcnt lgkmcnt(15)
    v_mfma_f32_32x32x16_bf16 v[208:223], a[52:55], a[144:147], v[208:223]
    ds_read_b64_tr_b16 a[4:5], v16 offset:12416
    ds_read_b64_tr_b16 a[6:7], v16 offset:13440
    buffer_load_dwordx4 v50, s[44:47], s9 offen offset:2048 lds
    v_mfma_f32_32x32x16_bf16 v[224:239], a[56:59], a[144:147], v[224:239]
    ds_read_b64_tr_b16 a[8:9], v17 offset:8192
    ds_read_b64_tr_b16 a[10:11], v17 offset:9216
    ds_read_b64_tr_b16 a[12:13], v18 offset:8192
    ds_read_b64_tr_b16 a[14:15], v18 offset:9216
    s_waitcnt lgkmcnt(15)
    v_mfma_f32_32x32x16_bf16 v[240:255], a[60:63], a[144:147], v[240:255]
    ds_read_b64_tr_b16 a[16:17], v19 offset:8192
    ds_read_b64_tr_b16 a[18:19], v19 offset:9216
    buffer_load_dwordx4 v51, s[44:47], s9 offen offset:3072 lds
    v_mfma_f32_32x32x16_bf16 v[128:143], a[64:67], a[148:151], v[128:143]
    ds_read_b64_tr_b16 a[20:21], v20 offset:8192
    ds_read_b64_tr_b16 a[22:23], v20 offset:9216
    s_waitcnt lgkmcnt(15)
    v_mfma_f32_32x32x16_bf16 v[144:159], a[68:71], a[148:151], v[144:159]
    ds_read_b64_tr_b16 a[24:25], v17 offset:8320
    ds_read_b64_tr_b16 a[26:27], v17 offset:9344
    s_add_u32 m0, s14, 0
    s_nop 0
    buffer_load_dwordx4 v5, s[64:67], s37 offen offset:0 lds
    v_mfma_f32_32x32x16_bf16 v[160:175], a[72:75], a[148:151], v[160:175]
    ds_read_b64_tr_b16 a[28:29], v18 offset:8320
    ds_read_b64_tr_b16 a[30:31], v18 offset:9344
    s_waitcnt lgkmcnt(15)
    v_mfma_f32_32x32x16_bf16 v[176:191], a[76:79], a[148:151], v[176:191]
    ds_read_b64_tr_b16 a[32:33], v19 offset:8320
    ds_read_b64_tr_b16 a[34:35], v19 offset:9344
    buffer_load_dwordx4 v6, s[64:67], s37 offen offset:1024 lds
    v_mfma_f32_32x32x16_bf16 v[192:207], a[80:83], a[148:151], v[192:207]
    ds_read_b64_tr_b16 a[36:37], v20 offset:8320
    ds_read_b64_tr_b16 a[38:39], v20 offset:9344
    s_waitcnt lgkmcnt(15)
    v_mfma_f32_32x32x16_bf16 v[208:223], a[84:87], a[148:151], v[208:223]
    ds_read_b64_tr_b16 a[40:41], v17 offset:12288
    ds_read_b64_tr_b16 a[42:43], v17 offset:13312
    ds_read_b64_tr_b16 a[44:45], v18 offset:12288
    ds_read_b64_tr_b16 a[46:47], v18 offset:13312
    buffer_load_dwordx4 v7, s[64:67], s37 offen offset:2048 lds
    v_mfma_f32_32x32x16_bf16 v[224:239], a[0:3], a[148:151], v[224:239]
    ds_read_b64_tr_b16 a[48:49], v19 offset:12288
    ds_read_b64_tr_b16 a[50:51], v19 offset:13312
    s_waitcnt vmcnt(7)
    s_mov_b64 exec, 0x1
    buffer_store_dword v31, v32, s[76:79], s81 offen sc1
    s_mov_b64 exec, -1
    s_waitcnt lgkmcnt(15)
    v_mfma_f32_32x32x16_bf16 v[240:255], a[4:7], a[148:151], v[240:255]
    ds_read_b64_tr_b16 a[52:53], v20 offset:12288
    ds_read_b64_tr_b16 a[54:55], v20 offset:13312
    buffer_load_dwordx4 v8, s[64:67], s37 offen offset:3072 lds
    v_mfma_f32_32x32x16_bf16 v[128:143], a[8:11], a[152:155], v[128:143]
    ds_read_b64_tr_b16 a[56:57], v17 offset:12416
    ds_read_b64_tr_b16 a[58:59], v17 offset:13440
    v_mfma_f32_32x32x16_bf16 v[144:159], a[12:15], a[152:155], v[144:159]
    ds_read_b64_tr_b16 a[60:61], v18 offset:12416
    ds_read_b64_tr_b16 a[62:63], v18 offset:13440
    s_add_u32 m0, s14, 4096
    s_nop 0
    buffer_load_dwordx4 v9, s[64:67], s37 offen offset:0 lds
    v_mfma_f32_32x32x16_bf16 v[160:175], a[16:19], a[152:155], v[160:175]
    ds_read_b64_tr_b16 a[64:65], v19 offset:12416
    ds_read_b64_tr_b16 a[66:67], v19 offset:13440
    buffer_load_dwordx4 v10, s[64:67], s37 offen offset:1024 lds
    buffer_load_dwordx4 v11, s[64:67], s37 offen offset:2048 lds
    buffer_load_dwordx4 v12, s[64:67], s37 offen offset:3072 lds
    s_waitcnt lgkmcnt(15)
    v_mfma_f32_32x32x16_bf16 v[176:191], a[20:23], a[152:155], v[176:191]
    ds_read_b64_tr_b16 a[68:69], v20 offset:12416
    ds_read_b64_tr_b16 a[70:71], v20 offset:13440
    v_mfma_f32_32x32x16_bf16 v[192:207], a[24:27], a[152:155], v[192:207]
    v_mfma_f32_32x32x16_bf16 v[208:223], a[28:31], a[152:155], v[208:223]
    v_mfma_f32_32x32x16_bf16 v[224:239], a[32:35], a[152:155], v[224:239]
    s_waitcnt lgkmcnt(14)
    v_mfma_f32_32x32x16_bf16 v[240:255], a[36:39], a[152:155], v[240:255]
    v_mfma_f32_32x32x16_bf16 v[128:143], a[40:43], a[156:159], v[128:143]
    s_waitcnt lgkmcnt(0)
    s_barrier
    ds_read_b64_tr_b16 a[72:73], v13 offset:16384
    ds_read_b64_tr_b16 a[74:75], v13 offset:17408
    ds_read_b64_tr_b16 a[76:77], v14 offset:16384
    ds_read_b64_tr_b16 a[78:79], v14 offset:17408
    v_mfma_f32_32x32x16_bf16 v[144:159], a[44:47], a[156:159], v[144:159]
    ds_read_b64_tr_b16 a[80:81], v15 offset:16384
    ds_read_b64_tr_b16 a[82:83], v15 offset:17408
    ds_read_b128 a[176:179], v1 offset:4096
    ds_read_b128 a[180:183], v2 offset:4096
    ds_read_b128 a[184:187], v3 offset:4096
    ds_read_b128 a[188:191], v4 offset:4096
    v_mfma_f32_32x32x16_bf16 v[160:175], a[48:51], a[156:159], v[160:175]
    ds_read_b64_tr_b16 a[84:85], v16 offset:16384
    ds_read_b64_tr_b16 a[86:87], v16 offset:17408
    v_mfma_f32_32x32x16_bf16 v[176:191], a[52:55], a[156:159], v[176:191]
    ds_read_b64_tr_b16 a[0:1], v13 offset:16512
    ds_read_b64_tr_b16 a[2:3], v13 offset:17536
    s_waitcnt lgkmcnt(4)
    s_add_u32 s9, s8, 7
    s_and_b32 s9, s9, 7
    s_lshl_b32 s9, s9, 7
    s_add_u32 m0, s18, 4096
    s_add_u32 s9, s9, s17
    buffer_load_dwordx4 v48, s[44:47], s9 offen offset:0 lds
    v_mfma_f32_32x32x16_bf16 v[192:207], a[56:59], a[156:159], v[192:207]
    ds_read_b64_tr_b16 a[4:5], v14 offset:16512
    ds_read_b64_tr_b16 a[6:7], v14 offset:17536
    v_mfma_f32_32x32x16_bf16 v[208:223], a[60:63], a[156:159], v[208:223]
    ds_read_b64_tr_b16 a[8:9], v15 offset:16512
    ds_read_b64_tr_b16 a[10:11], v15 offset:17536
    buffer_load_dwordx4 v49, s[44:47], s9 offen offset:1024 lds
    v_mfma_f32_32x32x16_bf16 v[224:239], a[64:67], a[156:159], v[224:239]
    ds_read_b64_tr_b16 a[12:13], v16 offset:16512
    ds_read_b64_tr_b16 a[14:15], v16 offset:17536
    v_mfma_f32_32x32x16_bf16 v[240:255], a[68:71], a[156:159], v[240:255]
    ds_read_b64_tr_b16 a[16:17], v13 offset:20480
    ds_read_b64_tr_b16 a[18:19], v13 offset:21504
    ds_read_b64_tr_b16 a[20:21], v14 offset:20480
    ds_read_b64_tr_b16 a[22:23], v14 offset:21504
    buffer_load_dwordx4 v50, s[44:47], s9 offen offset:2048 lds
    v_mfma_f32_32x32x16_bf16 v[128:143], a[72:75], a[160:163], v[128:143]
    ds_read_b64_tr_b16 a[24:25], v15 offset:20480
    ds_read_b64_tr_b16 a[26:27], v15 offset:21504
    v_mfma_f32_32x32x16_bf16 v[144:159], a[76:79], a[160:163], v[144:159]
    ds_read_b64_tr_b16 a[28:29], v16 offset:20480
    ds_read_b64_tr_b16 a[30:31], v16 offset:21504
    buffer_load_dwordx4 v51, s[44:47], s9 offen offset:3072 lds
    v_mfma_f32_32x32x16_bf16 v[160:175], a[80:83], a[160:163], v[160:175]
    ds_read_b64_tr_b16 a[32:33], v13 offset:20608
    ds_read_b64_tr_b16 a[34:35], v13 offset:21632
    s_waitcnt lgkmcnt(15)
    v_mfma_f32_32x32x16_bf16 v[176:191], a[84:87], a[160:163], v[176:191]
    ds_read_b64_tr_b16 a[36:37], v14 offset:20608
    ds_read_b64_tr_b16 a[38:39], v14 offset:21632
    s_add_u32 m0, s14, 8192
    s_nop 0
    buffer_load_dwordx4 v5, s[64:67], s38 offen offset:0 lds
    v_mfma_f32_32x32x16_bf16 v[192:207], a[0:3], a[160:163], v[192:207]
    ds_read_b64_tr_b16 a[40:41], v15 offset:20608
    ds_read_b64_tr_b16 a[42:43], v15 offset:21632
    s_waitcnt lgkmcnt(15)
    v_mfma_f32_32x32x16_bf16 v[208:223], a[4:7], a[160:163], v[208:223]
    ds_read_b64_tr_b16 a[44:45], v16 offset:20608
    ds_read_b64_tr_b16 a[46:47], v16 offset:21632
    buffer_load_dwordx4 v6, s[64:67], s38 offen offset:1024 lds
    v_mfma_f32_32x32x16_bf16 v[224:239], a[8:11], a[160:163], v[224:239]
    ds_read_b64_tr_b16 a[48:49], v17 offset:16384
    ds_read_b64_tr_b16 a[50:51], v17 offset:17408
    ds_read_b64_tr_b16 a[52:53], v18 offset:16384
    ds_read_b64_tr_b16 a[54:55], v18 offset:17408
    s_waitcnt lgkmcnt(15)
    v_mfma_f32_32x32x16_bf16 v[240:255], a[12:15], a[160:163], v[240:255]
    ds_read_b64_tr_b16 a[56:57], v19 offset:16384
    ds_read_b64_tr_b16 a[58:59], v19 offset:17408
    buffer_load_dwordx4 v7, s[64:67], s38 offen offset:2048 lds
    v_mfma_f32_32x32x16_bf16 v[128:143], a[16:19], a[164:167], v[128:143]
    ds_read_b64_tr_b16 a[60:61], v20 offset:16384
    ds_read_b64_tr_b16 a[62:63], v20 offset:17408
    s_waitcnt lgkmcnt(15)
    v_mfma_f32_32x32x16_bf16 v[144:159], a[20:23], a[164:167], v[144:159]
    ds_read_b64_tr_b16 a[64:65], v17 offset:16512
    ds_read_b64_tr_b16 a[66:67], v17 offset:17536
    buffer_load_dwordx4 v8, s[64:67], s38 offen offset:3072 lds
    v_mfma_f32_32x32x16_bf16 v[160:175], a[24:27], a[164:167], v[160:175]
    ds_read_b64_tr_b16 a[68:69], v18 offset:16512
    ds_read_b64_tr_b16 a[70:71], v18 offset:17536
    s_waitcnt lgkmcnt(15)
    v_mfma_f32_32x32x16_bf16 v[176:191], a[28:31], a[164:167], v[176:191]
    ds_read_b64_tr_b16 a[72:73], v19 offset:16512
    ds_read_b64_tr_b16 a[74:75], v19 offset:17536
    s_add_u32 m0, s14, 12288
    s_nop 0
    buffer_load_dwordx4 v9, s[64:67], s38 offen offset:0 lds
    v_mfma_f32_32x32x16_bf16 v[192:207], a[32:35], a[164:167], v[192:207]
    ds_read_b64_tr_b16 a[76:77], v20 offset:16512
    ds_read_b64_tr_b16 a[78:79], v20 offset:17536
    s_waitcnt lgkmcnt(15)
    v_mfma_f32_32x32x16_bf16 v[208:223], a[36:39], a[164:167], v[208:223]
    ds_read_b64_tr_b16 a[80:81], v17 offset:20480
    ds_read_b64_tr_b16 a[82:83], v17 offset:21504
    ds_read_b64_tr_b16 a[84:85], v18 offset:20480
    ds_read_b64_tr_b16 a[86:87], v18 offset:21504
    buffer_load_dwordx4 v10, s[64:67], s38 offen offset:1024 lds
    v_mfma_f32_32x32x16_bf16 v[224:239], a[40:43], a[164:167], v[224:239]
    ds_read_b64_tr_b16 a[0:1], v19 offset:20480
    ds_read_b64_tr_b16 a[2:3], v19 offset:21504
    s_waitcnt lgkmcnt(15)
    v_mfma_f32_32x32x16_bf16 v[240:255], a[44:47], a[164:167], v[240:255]
    ds_read_b64_tr_b16 a[4:5], v20 offset:20480
    ds_read_b64_tr_b16 a[6:7], v20 offset:21504
    buffer_load_dwordx4 v11, s[64:67], s38 offen offset:2048 lds
    v_mfma_f32_32x32x16_bf16 v[128:143], a[48:51], a[168:171], v[128:143]
    ds_read_b64_tr_b16 a[8:9], v17 offset:20608
    ds_read_b64_tr_b16 a[10:11], v17 offset:21632
    v_mfma_f32_32x32x16_bf16 v[144:159], a[52:55], a[168:171], v[144:159]
    ds_read_b64_tr_b16 a[12:13], v18 offset:20608
    ds_read_b64_tr_b16 a[14:15], v18 offset:21632
    buffer_load_dwordx4 v12, s[64:67], s38 offen offset:3072 lds
    v_mfma_f32_32x32x16_bf16 v[160:175], a[56:59], a[168:171], v[160:175]
    ds_read_b64_tr_b16 a[16:17], v19 offset:20608
    ds_read_b64_tr_b16 a[18:19], v19 offset:21632
    s_waitcnt lgkmcnt(15)
    v_mfma_f32_32x32x16_bf16 v[176:191], a[60:63], a[168:171], v[176:191]
    ds_read_b64_tr_b16 a[20:21], v20 offset:20608
    ds_read_b64_tr_b16 a[22:23], v20 offset:21632
    buffer_load_dwordx4 v[122:125], v33, s[60:63], s23 offen offset:0 nt
    v_mfma_f32_32x32x16_bf16 v[192:207], a[64:67], a[168:171], v[192:207]
    buffer_load_dwordx4 v[56:59], v33, s[60:63], s23 offen offset:1024 nt
    v_accvgpr_read_b32 v23, a241
    buffer_load_dwordx2 v[120:121], v23, s[60:63], 0 offen
    buffer_load_dwordx2 v[54:55], v33, s[60:63], s23 offen offset:1016
    v_mfma_f32_32x32x16_bf16 v[208:223], a[68:71], a[168:171], v[208:223]
    v_mfma_f32_32x32x16_bf16 v[224:239], a[72:75], a[168:171], v[224:239]
    s_waitcnt vmcnt(25)
    ds_read_b128 a[192:195], v1 offset:0
    ds_read_b128 a[196:199], v2 offset:0
    ds_read_b128 a[200:203], v3 offset:0
    ds_read_b128 a[204:207], v4 offset:0
    s_waitcnt lgkmcnt(15)
    v_mfma_f32_32x32x16_bf16 v[240:255], a[76:79], a[168:171], v[240:255]
    v_mfma_f32_32x32x16_bf16 v[128:143], a[80:83], a[172:175], v[128:143]
    s_waitcnt vmcnt(16) lgkmcnt(0)
    s_barrier
    ds_read_b64_tr_b16 a[24:25], v13 offset:0
    ds_read_b64_tr_b16 a[26:27], v13 offset:1024
    ds_read_b64_tr_b16 a[28:29], v14 offset:0
    ds_read_b64_tr_b16 a[30:31], v14 offset:1024
    v_mfma_f32_32x32x16_bf16 v[144:159], a[84:87], a[172:175], v[144:159]
    ds_read_b64_tr_b16 a[32:33], v15 offset:0
    ds_read_b64_tr_b16 a[34:35], v15 offset:1024
    s_add_u32 m0, s14, 16384
    s_nop 0
    buffer_load_dwordx4 v5, s[64:67], s39 offen offset:0 lds
    v_mfma_f32_32x32x16_bf16 v[160:175], a[0:3], a[172:175], v[160:175]
    ds_read_b64_tr_b16 a[36:37], v16 offset:0
    ds_read_b64_tr_b16 a[38:39], v16 offset:1024
    v_mfma_f32_32x32x16_bf16 v[176:191], a[4:7], a[172:175], v[176:191]
    ds_read_b64_tr_b16 a[40:41], v13 offset:128
    ds_read_b64_tr_b16 a[42:43], v13 offset:1152
    buffer_load_dwordx4 v6, s[64:67], s39 offen offset:1024 lds
    v_mfma_f32_32x32x16_bf16 v[192:207], a[8:11], a[172:175], v[192:207]
    ds_read_b64_tr_b16 a[44:45], v14 offset:128
    ds_read_b64_tr_b16 a[46:47], v14 offset:1152
    v_mfma_f32_32x32x16_bf16 v[208:223], a[12:15], a[172:175], v[208:223]
    ds_read_b64_tr_b16 a[48:49], v15 offset:128
    ds_read_b64_tr_b16 a[50:51], v15 offset:1152
    buffer_load_dwordx4 v7, s[64:67], s39 offen offset:2048 lds
    v_mfma_f32_32x32x16_bf16 v[224:239], a[16:19], a[172:175], v[224:239]
    ds_read_b64_tr_b16 a[52:53], v16 offset:128
    ds_read_b64_tr_b16 a[54:55], v16 offset:1152
    v_mfma_f32_32x32x16_bf16 v[240:255], a[20:23], a[172:175], v[240:255]
    ds_read_b64_tr_b16 a[56:57], v13 offset:4096
    ds_read_b64_tr_b16 a[58:59], v13 offset:5120
    ds_read_b64_tr_b16 a[60:61], v14 offset:4096
    ds_read_b64_tr_b16 a[62:63], v14 offset:5120
    buffer_load_dwordx4 v8, s[64:67], s39 offen offset:3072 lds
    s_waitcnt lgkmcnt(15)
    v_mfma_f32_32x32x16_bf16 v[128:143], a[24:27], a[176:179], v[128:143]
    ds_read_b64_tr_b16 a[64:65], v15 offset:4096
    ds_read_b64_tr_b16 a[66:67], v15 offset:5120
    s_waitcnt lgkmcnt(15)
    v_mfma_f32_32x32x16_bf16 v[144:159], a[28:31], a[176:179], v[144:159]
    ds_read_b64_tr_b16 a[68:69], v16 offset:4096
    ds_read_b64_tr_b16 a[70:71], v16 offset:5120
    s_add_u32 m0, s14, 20480
    s_nop 0
    buffer_load_dwordx4 v9, s[64:67], s39 offen offset:0 lds
    v_mfma_f32_32x32x16_bf16 v[160:175], a[32:35], a[176:179], v[160:175]
    ds_read_b64_tr_b16 a[72:73], v13 offset:4224
    ds_read_b64_tr_b16 a[74:75], v13 offset:5248
    s_waitcnt lgkmcnt(15)
    v_mfma_f32_32x32x16_bf16 v[176:191], a[36:39], a[176:179], v[176:191]
    ds_read_b64_tr_b16 a[76:77], v14 offset:4224
    ds_read_b64_tr_b16 a[78:79], v14 offset:5248
    buffer_load_dwordx4 v10, s[64:67], s39 offen offset:1024 lds
    v_mfma_f32_32x32x16_bf16 v[192:207], a[40:43], a[176:179], v[192:207]
    ds_read_b64_tr_b16 a[80:81], v15 offset:4224
    ds_read_b64_tr_b16 a[82:83], v15 offset:5248
    s_waitcnt lgkmcnt(15)
    v_mfma_f32_32x32x16_bf16 v[208:223], a[44:47], a[176:179], v[208:223]
    ds_read_b64_tr_b16 a[84:85], v16 offset:4224
    ds_read_b64_tr_b16 a[86:87], v16 offset:5248
    buffer_load_dwordx4 v11, s[64:67], s39 offen offset:2048 lds
    v_mfma_f32_32x32x16_bf16 v[224:239], a[48:51], a[176:179], v[224:239]
    ds_read_b64_tr_b16 a[0:1], v17 offset:0
    ds_read_b64_tr_b16 a[2:3], v17 offset:1024
    ds_read_b64_tr_b16 a[4:5], v18 offset:0
    ds_read_b64_tr_b16 a[6:7], v18 offset:1024
    s_waitcnt lgkmcnt(15)
    v_mfma_f32_32x32x16_bf16 v[240:255], a[52:55], a[176:179], v[240:255]
    ds_read_b64_tr_b16 a[8:9], v19 offset:0
    ds_read_b64_tr_b16 a[10:11], v19 offset:1024
    buffer_load_dwordx4 v12, s[64:67], s39 offen offset:3072 lds
    v_mfma_f32_32x32x16_bf16 v[128:143], a[56:59], a[180:183], v[128:143]
    ds_read_b64_tr_b16 a[12:13], v20 offset:0
    ds_read_b64_tr_b16 a[14:15], v20 offset:1024
    s_waitcnt lgkmcnt(15)
    v_mfma_f32_32x32x16_bf16 v[144:159], a[60:63], a[180:183], v[144:159]
    ds_read_b64_tr_b16 a[16:17], v17 offset:128
    ds_read_b64_tr_b16 a[18:19], v17 offset:1152
    v_mfma_f32_32x32x16_bf16 v[160:175], a[64:67], a[180:183], v[160:175]
    ds_read_b64_tr_b16 a[20:21], v18 offset:128
    ds_read_b64_tr_b16 a[22:23], v18 offset:1152
    s_waitcnt lgkmcnt(15)
    v_mfma_f32_32x32x16_bf16 v[176:191], a[68:71], a[180:183], v[176:191]
    ds_read_b64_tr_b16 a[24:25], v19 offset:128
    ds_read_b64_tr_b16 a[26:27], v19 offset:1152
    v_mfma_f32_32x32x16_bf16 v[192:207], a[72:75], a[180:183], v[192:207]
    ds_read_b64_tr_b16 a[28:29], v20 offset:128
    ds_read_b64_tr_b16 a[30:31], v20 offset:1152
    v_mov_b32 v100, 0
    v_mov_b32 v101, 0
    v_mov_b32 v102, 0
    s_waitcnt lgkmcnt(15)
    v_mfma_f32_32x32x16_bf16 v[208:223], a[76:79], a[180:183], v[208:223]
    ds_read_b64_tr_b16 a[32:33], v17 offset:4096
    ds_read_b64_tr_b16 a[34:35], v17 offset:5120
    ds_read_b64_tr_b16 a[36:37], v18 offset:4096
    ds_read_b64_tr_b16 a[38:39], v18 offset:5120
    v_mov_b32 v103, 0
    v_mov_b32 v104, 0
    v_mfma_f32_32x32x16_bf16 v[224:239], a[80:83], a[180:183], v[224:239]
    ds_read_b64_tr_b16 a[40:41], v19 offset:4096
    ds_read_b64_tr_b16 a[42:43], v19 offset:5120
    s_waitcnt vmcnt(20)
    ds_read_b128 a[208:211], v1 offset:4096
    ds_read_b128 a[212:215], v2 offset:4096
    ds_read_b128 a[216:219], v3 offset:4096
    ds_read_b128 a[220:223], v4 offset:4096
    s_waitcnt lgkmcnt(15)
    v_mfma_f32_32x32x16_bf16 v[240:255], a[84:87], a[180:183], v[240:255]
    ds_read_b64_tr_b16 a[44:45], v20 offset:4096
    ds_read_b64_tr_b16 a[46:47], v20 offset:5120
    v_mov_b32 v105, 0
    v_mov_b32 v106, 0
    v_mov_b32 v107, 0
    v_mov_b32 v110, 0
    v_mfma_f32_32x32x16_bf16 v[128:143], a[0:3], a[184:187], v[128:143]
    ds_read_b64_tr_b16 a[48:49], v17 offset:4224
    ds_read_b64_tr_b16 a[50:51], v17 offset:5248
    s_add_u32 m0, s82, 0
    s_nop 0
    buffer_load_dwordx4 v36, s[68:71], s40 offen offset:0 lds
    v_accvgpr_read_b32 v21, a240
    v_mfma_f32_32x32x16_bf16 v[144:159], a[4:7], a[184:187], v[144:159]
    ds_read_b64_tr_b16 a[52:53], v18 offset:4224
    ds_read_b64_tr_b16 a[54:55], v18 offset:5248
    v_mov_b32 v60, 0
    v_mov_b32 v61, 0
    v_mov_b32 v62, 0
    v_mov_b32 v63, 0
    v_mfma_f32_32x32x16_bf16 v[160:175], a[8:11], a[184:187], v[160:175]
    ds_read_b64_tr_b16 a[56:57], v19 offset:4224
    ds_read_b64_tr_b16 a[58:59], v19 offset:5248
    buffer_load_dwordx4 v37, s[68:71], s40 offen offset:1024 lds
    s_waitcnt vmcnt(11)
    v_alignbit_b32 v64, v121, v120, 16
    v_alignbit_b32 v65, v122, v121, 16
    v_mfma_f32_32x32x16_bf16 v[176:191], a[12:15], a[184:187], v[176:191]
    ds_read_b64_tr_b16 a[60:61], v20 offset:4224
    ds_read_b64_tr_b16 a[62:63], v20 offset:5248
    v_alignbit_b32 v66, v123, v122, 16
    v_alignbit_b32 v67, v124, v123, 16
    v_mov_b32 v68, v121
    v_mov_b32 v69, v122
    v_mfma_f32_32x32x16_bf16 v[192:207], a[16:19], a[184:187], v[192:207]
    s_add_u32 s40, s40, 16384
    s_add_u32 m0, s82, 2048
    s_nop 0
    buffer_load_dwordx4 v36, s[68:71], s40 offen offset:0 lds
    v_mov_b32 v70, v123
    v_mov_b32 v71, v124
    s_waitcnt lgkmcnt(15)
    v_mfma_f32_32x32x16_bf16 v[208:223], a[20:23], a[184:187], v[208:223]
    v_alignbit_b32 v72, v122, v121, 16
    v_alignbit_b32 v73, v123, v122, 16
    v_alignbit_b32 v74, v124, v123, 16
    v_alignbit_b32 v75, v125, v124, 16
    s_waitcnt vmcnt(11)
    v_alignbit_b32 v76, v55, v54, 16
    v_alignbit_b32 v77, v56, v55, 16
    v_mfma_f32_32x32x16_bf16 v[224:239], a[24:27], a[184:187], v[224:239]
    buffer_load_dwordx4 v37, s[68:71], s40 offen offset:1024 lds
    v_alignbit_b32 v78, v57, v56, 16
    v_alignbit_b32 v79, v58, v57, 16
    v_mov_b32 v80, v55
    v_mov_b32 v81, v56
    v_mfma_f32_32x32x16_bf16 v[240:255], a[28:31], a[184:187], v[240:255]
    v_mov_b32 v82, v57
    v_mov_b32 v83, v58
    v_alignbit_b32 v84, v56, v55, 16
    v_alignbit_b32 v85, v57, v56, 16
    v_alignbit_b32 v86, v58, v57, 16
    v_alignbit_b32 v87, v59, v58, 16
    v_mfma_f32_32x32x16_bf16 v[128:143], a[32:35], a[188:191], v[128:143]
    s_waitcnt lgkmcnt(0)
    s_barrier
    ds_read_b64_tr_b16 a[64:65], v13 offset:8192
    ds_read_b64_tr_b16 a[66:67], v13 offset:9216
    ds_read_b64_tr_b16 a[68:69], v14 offset:8192
    ds_read_b64_tr_b16 a[70:71], v14 offset:9216
    s_add_u32 s40, s40, 16384
    s_add_u32 m0, s82, 4096
    s_nop 0
    buffer_load_dwordx4 v36, s[68:71], s40 offen offset:0 lds
    buffer_load_dwordx4 v37, s[68:71], s40 offen offset:1024 lds
    s_add_u32 s40, s40, 16384
    v_mfma_f32_32x32x16_bf16 v[144:159], a[36:39], a[188:191], v[144:159]
    ds_read_b64_tr_b16 a[72:73], v15 offset:8192
    ds_read_b64_tr_b16 a[74:75], v15 offset:9216
    ds_read_b64_tr_b16 a[76:77], v16 offset:8192
    ds_read_b64_tr_b16 a[78:79], v16 offset:9216
    v_accvgpr_read_b32 v127, a242
    v_mov_b32 v126, s12
    s_mov_b64 exec, 0xf
    buffer_load_dword v126, v127, s[76:79], 0 offen sc1
    s_mov_b64 exec, -1
    v_mfma_f32_32x32x16_bf16 v[160:175], a[40:43], a[188:191], v[160:175]
    ds_read_b64_tr_b16 a[80:81], v13 offset:8320
    ds_read_b64_tr_b16 a[82:83], v13 offset:9344
    v_mov_b32 v34, s12
    s_mov_b32 exec_hi, 0
    buffer_load_dword v34, v35, s[76:79], s85 offen sc1
    s_mov_b32 exec_hi, -1
    v_mfma_f32_32x32x16_bf16 v[176:191], a[44:47], a[188:191], v[176:191]
    ds_read_b64_tr_b16 a[84:85], v14 offset:8320
    ds_read_b64_tr_b16 a[86:87], v14 offset:9344
    ds_read_b64_tr_b16 a[0:1], v15 offset:8320
    ds_read_b64_tr_b16 a[2:3], v15 offset:9344
    s_add_u32 m0, s14, 0
    s_nop 0
    buffer_load_dwordx4 v36, s[68:71], s40 offen offset:0 lds
    v_mfma_f32_32x32x16_bf16 v[192:207], a[48:51], a[188:191], v[192:207]
    ds_read_b64_tr_b16 a[4:5], v16 offset:8320
    ds_read_b64_tr_b16 a[6:7], v16 offset:9344
    v_mfma_f32_32x32x16_bf16 v[208:223], a[52:55], a[188:191], v[208:223]
    ds_read_b64_tr_b16 a[8:9], v13 offset:12288
    ds_read_b64_tr_b16 a[10:11], v13 offset:13312
    ds_read_b64_tr_b16 a[12:13], v14 offset:12288
    ds_read_b64_tr_b16 a[14:15], v14 offset:13312
    buffer_load_dwordx4 v37, s[68:71], s40 offen offset:1024 lds
    v_mfma_f32_32x32x16_bf16 v[224:239], a[56:59], a[188:191], v[224:239]
    ds_read_b64_tr_b16 a[16:17], v15 offset:12288
    ds_read_b64_tr_b16 a[18:19], v15 offset:13312
    ds_read_b64_tr_b16 a[20:21], v16 offset:12288
    ds_read_b64_tr_b16 a[22:23], v16 offset:13312
    v_mfma_f32_32x32x16_bf16 v[240:255], a[60:63], a[188:191], v[240:255]
    ds_read_b64_tr_b16 a[24:25], v13 offset:12416
    ds_read_b64_tr_b16 a[26:27], v13 offset:13440
    s_add_u32 s40, s40, 16384
    s_add_u32 m0, s14, 2048
    s_nop 0
    buffer_load_dwordx4 v36, s[68:71], s40 offen offset:0 lds
    s_waitcnt lgkmcnt(15)
    v_mfma_f32_32x32x16_bf16 v[128:143], a[64:67], a[192:195], v[128:143]
    ds_read_b64_tr_b16 a[28:29], v14 offset:12416
    ds_read_b64_tr_b16 a[30:31], v14 offset:13440
    ds_read_b64_tr_b16 a[32:33], v15 offset:12416
    ds_read_b64_tr_b16 a[34:35], v15 offset:13440
    v_mfma_f32_32x32x16_bf16 v[144:159], a[68:71], a[192:195], v[144:159]
    ds_read_b64_tr_b16 a[36:37], v16 offset:12416
    ds_read_b64_tr_b16 a[38:39], v16 offset:13440
    buffer_load_dwordx4 v37, s[68:71], s40 offen offset:1024 lds
    v_mfma_f32_32x32x16_bf16 v[160:175], a[72:75], a[192:195], v[160:175]
    ds_read_b64_tr_b16 a[40:41], v17 offset:8192
    ds_read_b64_tr_b16 a[42:43], v17 offset:9216
    ds_read_b64_tr_b16 a[44:45], v18 offset:8192
    ds_read_b64_tr_b16 a[46:47], v18 offset:9216
    v_mfma_f32_32x32x16_bf16 v[176:191], a[76:79], a[192:195], v[176:191]
    ds_read_b64_tr_b16 a[48:49], v19 offset:8192
    ds_read_b64_tr_b16 a[50:51], v19 offset:9216
    ds_read_b64_tr_b16 a[52:53], v20 offset:8192
    ds_read_b64_tr_b16 a[54:55], v20 offset:9216
    s_add_u32 s40, s40, 16384
    s_add_u32 m0, s14, 4096
    s_nop 0
    buffer_load_dwordx4 v36, s[68:71], s40 offen offset:0 lds
    v_mfma_f32_32x32x16_bf16 v[192:207], a[80:83], a[192:195], v[192:207]
    ds_read_b64_tr_b16 a[56:57], v17 offset:8320
    ds_read_b64_tr_b16 a[58:59], v17 offset:9344
    s_waitcnt lgkmcnt(15)
    v_mfma_f32_32x32x16_bf16 v[208:223], a[84:87], a[192:195], v[208:223]
    ds_read_b64_tr_b16 a[60:61], v18 offset:8320
    ds_read_b64_tr_b16 a[62:63], v18 offset:9344
    ds_read_b64_tr_b16 a[64:65], v19 offset:8320
    ds_read_b64_tr_b16 a[66:67], v19 offset:9344
    buffer_load_dwordx4 v37, s[68:71], s40 offen offset:1024 lds
    v_mfma_f32_32x32x16_bf16 v[224:239], a[0:3], a[192:195], v[224:239]
    ds_read_b64_tr_b16 a[68:69], v20 offset:8320
    ds_read_b64_tr_b16 a[70:71], v20 offset:9344
    v_mfma_f32_32x32x16_bf16 v[240:255], a[4:7], a[192:195], v[240:255]
    ds_read_b64_tr_b16 a[72:73], v17 offset:12288
    ds_read_b64_tr_b16 a[74:75], v17 offset:13312
    ds_read_b64_tr_b16 a[76:77], v18 offset:12288
    ds_read_b64_tr_b16 a[78:79], v18 offset:13312
    s_add_u32 s40, s40, 16384
    s_add_u32 m0, s14, 6144
    s_nop 0
    buffer_load_dwordx4 v36, s[68:71], s40 offen offset:0 lds
    v_mfma_f32_32x32x16_bf16 v[128:143], a[8:11], a[196:199], v[128:143]
    ds_read_b64_tr_b16 a[80:81], v19 offset:12288
    ds_read_b64_tr_b16 a[82:83], v19 offset:13312
    ds_read_b64_tr_b16 a[84:85], v20 offset:12288
    ds_read_b64_tr_b16 a[86:87], v20 offset:13312
    s_waitcnt vmcnt(9)
    v_mfma_f32_32x32x16_bf16 v[144:159], a[12:15], a[196:199], v[144:159]
    ds_read_b64_tr_b16 a[0:1], v17 offset:12416
    ds_read_b64_tr_b16 a[2:3], v17 offset:13440
    buffer_load_dwordx4 v37, s[68:71], s40 offen offset:1024 lds
    s_add_u32 s40, s40, 16384
    ds_read_b64_tr_b16 a[96:97], v52 offset:0
    ds_read_b64_tr_b16 a[98:99], v52 offset:1024
    v_mfma_f32_32x32x16_bf16 v[160:175], a[16:19], a[196:199], v[160:175]
    ds_read_b64_tr_b16 a[4:5], v18 offset:12416
    ds_read_b64_tr_b16 a[6:7], v18 offset:13440
    ds_read_b64_tr_b16 a[8:9], v19 offset:12416
    ds_read_b64_tr_b16 a[10:11], v19 offset:13440
    ds_read_b64_tr_b16 a[100:101], v53 offset:0
    v_mfma_f32_32x32x16_bf16 v[176:191], a[20:23], a[196:199], v[176:191]
    ds_read_b64_tr_b16 a[12:13], v20 offset:12416
    ds_read_b64_tr_b16 a[14:15], v20 offset:13440
    ds_read_b64_tr_b16 a[102:103], v53 offset:1024
    ds_read_b64_tr_b16 a[104:105], v52 offset:2048
    ds_read_b64_tr_b16 a[106:107], v52 offset:3072
    ds_read_b64_tr_b16 a[108:109], v53 offset:2048
    v_mfma_f32_32x32x16_bf16 v[192:207], a[24:27], a[196:199], v[192:207]
    ds_read_b64_tr_b16 a[110:111], v53 offset:3072
    ds_read_b64_tr_b16 a[112:113], v52 offset:4096
    ds_read_b64_tr_b16 a[114:115], v52 offset:5120
    ds_read_b64_tr_b16 a[116:117], v53 offset:4096
    ds_read_b64_tr_b16 a[118:119], v53 offset:5120
    s_waitcnt lgkmcnt(15)
    v_mfma_f32_32x32x16_bf16 v[208:223], a[28:31], a[196:199], v[208:223]
    ds_write_b128 v21, v[60:63]
    v_mfma_f32_32x32x16_bf16 v[224:239], a[32:35], a[196:199], v[224:239]
    s_waitcnt vmcnt(9)
    v_cmp_ne_u32 vcc, s12, v126
    s_nop 1
    s_cbranch_vccnz L_slow0
L_back0:
    s_lshl_b32 s10, s5, 10
    s_add_u32 s10, s10, 12648448
    v_lshrrev_b32 v23, 2, v35
    s_mov_b32 exec_hi, 0
    buffer_load_dwordx4 v[100:103], v23, s[76:79], s10 offen sc1
    s_mov_b32 exec_hi, -1
    ds_write_b128 v27, v[122:125] offset:13536
    v_mfma_f32_32x32x16_bf16 v[240:255], a[36:39], a[196:199], v[240:255]
    s_mov_b32 exec_hi, 0
    buffer_load_dwordx4 v[104:107], v23, s[76:79], s10 offen offset:16 sc1
    s_mov_b32 exec_hi, -1
    ds_write_b128 v27, v[64:67] offset:0
    v_mov_b32 v108, 0
    v_mov_b32 v109, 0
    v_mfma_f32_32x32x16_bf16 v[128:143], a[40:43], a[200:203], v[128:143]
    s_lshr_b32 s10, s17, 6
    s_add_u32 s10, s10, 12582920
    v_lshrrev_b32 v23, 5, v0
    v_lshl_add_u32 v23, v23, 24, v33
    s_mov_b32 exec_hi, 0
    buffer_load_dword v110, v23, s[76:79], s10 offen sc1
    s_mov_b32 exec_hi, -1
    ds_write_b128 v27, v[68:71] offset:4512
    v_mfma_f32_32x32x16_bf16 v[144:159], a[44:47], a[200:203], v[144:159]
    s_waitcnt vmcnt(11)
    v_cmp_ne_u32 vcc, s12, v34
    s_nop 1
    s_cbranch_vccnz L_slow1
L_back1:
    s_add_u32 s23, s23, 8388608
    buffer_load_dwordx4 v[40:43], v33, s[76:79], s23 offen sc1
    v_mov_b32 v111, 0
    v_mov_b32 v112, 0
    v_mfma_f32_32x32x16_bf16 v[160:175], a[48:51], a[200:203], v[160:175]
    buffer_load_dwordx4 v[44:47], v33, s[76:79], s23 offen offset:1024 sc1
    ds_write_b128 v27, v[72:75] offset:9024
    v_mov_b32 v113, 0
    v_mov_b32 v114, 0
    v_mov_b32 v115, 0
    v_mfma_f32_32x32x16_bf16 v[176:191], a[52:55], a[200:203], v[176:191]
    ds_write_b128 v27, v[56:59] offset:14560
    v_mov_b32 v116, 0
    v_mov_b32 v118, 0
    v_mov_b32 v119, 0
    v_mfma_f32_32x32x16_bf16 v[192:207], a[56:59], a[200:203], v[192:207]
    ds_write_b128 v27, v[76:79] offset:1024
    v_mfma_f32_32x32x16_bf16 v[208:223], a[60:63], a[200:203], v[208:223]
    v_mfma_f32_32x32x16_bf16 v[224:239], a[64:67], a[200:203], v[224:239]
    v_mfma_f32_32x32x16_bf16 v[240:255], a[68:71], a[200:203], v[240:255]
    v_mfma_f32_32x32x16_bf16 v[128:143], a[72:75], a[204:207], v[128:143]
    s_waitcnt lgkmcnt(0)
    s_barrier
    ds_read_b64_tr_b16 a[16:17], v13 offset:16384
    ds_read_b64_tr_b16 a[18:19], v13 offset:17408
    ds_read_b64_tr_b16 a[20:21], v13 offset:20480
    ds_read_b64_tr_b16 a[22:23], v13 offset:21504
    v_mfma_f32_32x32x16_bf16 v[144:159], a[76:79], a[204:207], v[144:159]
    ds_read_b64_tr_b16 a[24:25], v17 offset:16384
    ds_read_b64_tr_b16 a[26:27], v17 offset:17408
    ds_read_b64_tr_b16 a[28:29], v17 offset:20480
    ds_read_b64_tr_b16 a[30:31], v17 offset:21504
    s_add_u32 m0, s14, 8192
    s_nop 0
    buffer_load_dwordx4 v36, s[68:71], s40 offen offset:0 lds
    v_mfma_f32_32x32x16_bf16 v[160:175], a[80:83], a[204:207], v[160:175]
    ds_read_b64_tr_b16 a[32:33], v14 offset:16384
    ds_read_b64_tr_b16 a[34:35], v14 offset:17408
    v_mfma_f32_32x32x16_bf16 v[176:191], a[84:87], a[204:207], v[176:191]
    ds_read_b64_tr_b16 a[36:37], v14 offset:20480
    ds_read_b64_tr_b16 a[38:39], v14 offset:21504
    ds_read_b64_tr_b16 a[40:41], v18 offset:16384
    ds_read_b64_tr_b16 a[42:43], v18 offset:17408
    buffer_load_dwordx4 v37, s[68:71], s40 offen offset:1024 lds
    v_mfma_f32_32x32x16_bf16 v[192:207], a[0:3], a[204:207], v[192:207]
    ds_read_b64_tr_b16 a[44:45], v18 offset:20480
    ds_read_b64_tr_b16 a[46:47], v18 offset:21504
    v_mfma_f32_32x32x16_bf16 v[208:223], a[4:7], a[204:207], v[208:223]
    ds_read_b64_tr_b16 a[48:49], v15 offset:16384
    ds_read_b64_tr_b16 a[50:51], v15 offset:17408
    ds_read_b64_tr_b16 a[52:53], v15 offset:20480
    ds_read_b64_tr_b16 a[54:55], v15 offset:21504
    s_add_u32 s40, s40, 16384
    s_add_u32 m0, s14, 10240
    s_nop 0
    buffer_load_dwordx4 v36, s[68:71], s40 offen offset:0 lds
    v_mfma_f32_32x32x16_bf16 v[224:239], a[8:11], a[204:207], v[224:239]
    ds_read_b64_tr_b16 a[56:57], v19 offset:16384
    ds_read_b64_tr_b16 a[58:59], v19 offset:17408
    ds_read_b64_tr_b16 a[60:61], v19 offset:20480
    ds_read_b64_tr_b16 a[62:63], v19 offset:21504
    v_mfma_f32_32x32x16_bf16 v[240:255], a[12:15], a[204:207], v[240:255]
    ds_read_b64_tr_b16 a[64:65], v16 offset:16384
    ds_read_b64_tr_b16 a[66:67], v16 offset:17408
    buffer_load_dwordx4 v37, s[68:71], s40 offen offset:1024 lds
    s_waitcnt lgkmcnt(15)
    v_mfma_f32_32x32x16_bf16 v[128:143], a[16:19], a[208:211], v[128:143]
    ds_read_b64_tr_b16 a[68:69], v16 offset:20480
    ds_read_b64_tr_b16 a[70:71], v16 offset:21504
    ds_read_b64_tr_b16 a[72:73], v20 offset:16384
    ds_read_b64_tr_b16 a[74:75], v20 offset:17408
    v_mfma_f32_32x32x16_bf16 v[128:143], a[20:23], a[212:215], v[128:143]
    ds_read_b64_tr_b16 a[76:77], v20 offset:20480
    ds_read_b64_tr_b16 a[78:79], v20 offset:21504
    s_waitcnt vmcnt(6)
    v_mov_b32 v117, v110
    s_add_u32 s40, s40, 16384
    s_add_u32 m0, s14, 12288
    s_nop 0
    buffer_load_dwordx4 v36, s[68:71], s40 offen offset:0 lds
    v_mfma_f32_32x32x16_bf16 v[128:143], a[24:27], a[216:219], v[128:143]
    ds_read_b64_tr_b16 a[80:81], v13 offset:16512
    ds_read_b64_tr_b16 a[82:83], v13 offset:17536
    ds_read_b64_tr_b16 a[84:85], v13 offset:20608
    ds_read_b64_tr_b16 a[86:87], v13 offset:21632
    v_mfma_f32_32x32x16_bf16 v[128:143], a[28:31], a[220:223], v[128:143]
    ds_read_b64_tr_b16 a[0:1], v17 offset:16512
    ds_read_b64_tr_b16 a[2:3], v17 offset:17536
    ds_read_b64_tr_b16 a[4:5], v17 offset:20608
    ds_read_b64_tr_b16 a[6:7], v17 offset:21632
    buffer_load_dwordx4 v37, s[68:71], s40 offen offset:1024 lds
    v_mfma_f32_32x32x16_bf16 v[128:143], v[100:103], v[110:113], v[128:143]
    ds_read_b64_tr_b16 a[8:9], v14 offset:16512
    ds_read_b64_tr_b16 a[10:11], v14 offset:17536
    v_mfma_f32_32x32x16_bf16 v[144:159], a[32:35], a[208:211], v[144:159]
    ds_read_b64_tr_b16 a[12:13], v14 offset:20608
    ds_read_b64_tr_b16 a[14:15], v14 offset:21632
    ds_read_b64_tr_b16 a[16:17], v18 offset:16512
    ds_read_b64_tr_b16 a[18:19], v18 offset:17536
    s_waitcnt lgkmcnt(15)
    v_mfma_f32_32x32x16_bf16 v[144:159], a[36:39], a[212:215], v[144:159]
    ds_read_b64_tr_b16 a[20:21], v18 offset:20608
    ds_read_b64_tr_b16 a[22:23], v18 offset:21632
    s_add_u32 s40, s40, 16384
    s_add_u32 m0, s14, 14336
    s_nop 0
    buffer_load_dwordx4 v36, s[68:71], s40 offen offset:0 lds
    v_max_f32 v128, 0, v128
    v_max_f32 v129, 0, v129
    v_mfma_f32_32x32x16_bf16 v[144:159], a[40:43], a[216:219], v[144:159]
    ds_read_b64_tr_b16 a[24:25], v15 offset:16512
    ds_read_b64_tr_b16 a[26:27], v15 offset:17536
    ds_read_b64_tr_b16 a[28:29], v15 offset:20608
    ds_read_b64_tr_b16 a[30:31], v15 offset:21632
    v_max_f32 v130, 0, v130
    v_max_f32 v131, 0, v131
    v_mfma_f32_32x32x16_bf16 v[144:159], a[44:47], a[220:223], v[144:159]
    ds_read_b64_tr_b16 a[32:33], v19 offset:16512
    ds_read_b64_tr_b16 a[34:35], v19 offset:17536
    ds_read_b64_tr_b16 a[36:37], v19 offset:20608
    ds_read_b64_tr_b16 a[38:39], v19 offset:21632
    buffer_load_dwordx4 v37, s[68:71], s40 offen offset:1024 lds
    s_add_u32 s40, s40, 16384
    v_max_f32 v132, 0, v132
    v_mfma_f32_32x32x16_bf16 v[144:159], v[100:103], v[116:119], v[144:159]
    ds_read_b64_tr_b16 a[40:41], v16 offset:16512
    ds_read_b64_tr_b16 a[42:43], v16 offset:17536
    v_max_f32 v133, 0, v133
    v_max_f32 v134, 0, v134
    v_max_f32 v135, 0, v135
    v_mul_f32 v128, v128, v136
    v_mul_f32 v129, v129, v137
    v_mfma_f32_32x32x16_bf16 v[160:175], a[48:51], a[208:211], v[160:175]
    ds_read_b64_tr_b16 a[44:45], v16 offset:20608
    ds_read_b64_tr_b16 a[46:47], v16 offset:21632
    v_mul_f32 v130, v130, v138
    v_mul_f32 v131, v131, v139
    v_mul_f32 v132, v132, v140
    v_mul_f32 v133, v133, v141
    v_mfma_f32_32x32x16_bf16 v[160:175], a[52:55], a[212:215], v[160:175]
    ds_read_b64_tr_b16 a[48:49], v20 offset:16512
    ds_read_b64_tr_b16 a[50:51], v20 offset:17536
    v_mul_f32 v134, v134, v142
    v_mul_f32 v135, v135, v143
    v_cvt_pk_bf16_f32 v136, v128, v129
    v_cvt_pk_bf16_f32 v137, v130, v131
    v_cvt_pk_bf16_f32 v138, v132, v133
    v_mfma_f32_32x32x16_bf16 v[160:175], a[56:59], a[216:219], v[160:175]
    ds_read_b64_tr_b16 a[52:53], v20 offset:20608
    ds_read_b64_tr_b16 a[54:55], v20 offset:21632
    v_cvt_pk_bf16_f32 v139, v134, v135
    buffer_store_dwordx4 v[136:139], v33, s[76:79], s43 offen offset:0 sc1
    v_max_f32 v144, 0, v144
    v_max_f32 v145, 0, v145
    v_mfma_f32_32x32x16_bf16 v[160:175], a[60:63], a[220:223], v[160:175]
    v_max_f32 v146, 0, v146
    v_max_f32 v147, 0, v147
    v_max_f32 v148, 0, v148
    v_max_f32 v149, 0, v149
    v_max_f32 v150, 0, v150
    v_max_f32 v151, 0, v151
    v_mul_f32 v144, v144, v152
    v_mfma_f32_32x32x16_bf16 v[160:175], v[100:103], v[108:111], v[160:175]
    v_mul_f32 v145, v145, v153
    v_mul_f32 v146, v146, v154
    v_mul_f32 v147, v147, v155
    v_mul_f32 v148, v148, v156
    v_mul_f32 v149, v149, v157
    v_mul_f32 v150, v150, v158
    v_mul_f32 v151, v151, v159
    v_mfma_f32_32x32x16_bf16 v[176:191], a[64:67], a[208:211], v[176:191]
    v_cvt_pk_bf16_f32 v152, v144, v145
    v_cvt_pk_bf16_f32 v153, v146, v147
    v_cvt_pk_bf16_f32 v154, v148, v149
    v_cvt_pk_bf16_f32 v155, v150, v151
    buffer_store_dwordx4 v[152:155], v33, s[76:79], s43 offen offset:1024 sc1
    v_mfma_f32_32x32x16_bf16 v[176:191], a[68:71], a[212:215], v[176:191]
    ds_write_b128 v27, v[80:83] offset:5536
    v_max_f32 v160, 0, v160
    v_max_f32 v161, 0, v161
    v_max_f32 v162, 0, v162
    v_max_f32 v163, 0, v163
    v_max_f32 v164, 0, v164
    v_max_f32 v165, 0, v165
    v_mfma_f32_32x32x16_bf16 v[176:191], a[72:75], a[216:219], v[176:191]
    ds_write_b128 v27, v[84:87] offset:10048
    s_waitcnt lgkmcnt(15)
    v_max_f32 v166, 0, v166
    v_max_f32 v167, 0, v167
    v_mul_f32 v160, v160, v168
    v_mul_f32 v161, v161, v169
    v_mul_f32 v162, v162, v170
    v_mfma_f32_32x32x16_bf16 v[176:191], a[76:79], a[220:223], v[176:191]
    ds_write_b64 v28, v[60:61]
    v_mul_f32 v163, v163, v171
    v_mul_f32 v164, v164, v172
    v_mul_f32 v165, v165, v173
    v_mul_f32 v166, v166, v174
    v_mul_f32 v167, v167, v175
    v_cvt_pk_bf16_f32 v168, v160, v161
    v_mfma_f32_32x32x16_bf16 v[176:191], v[100:103], v[114:117], v[176:191]
    v_cvt_pk_bf16_f32 v169, v162, v163
    v_cvt_pk_bf16_f32 v170, v164, v165
    v_cvt_pk_bf16_f32 v171, v166, v167
    buffer_store_dwordx4 v[168:171], v33, s[76:79], s43 offen offset:2048 sc1
    v_mfma_f32_32x32x16_bf16 v[192:207], a[80:83], a[208:211], v[192:207]
    s_waitcnt vmcnt(12)
    ds_write_b128 v29, v[40:43] offset:0
    v_mfma_f32_32x32x16_bf16 v[192:207], a[84:87], a[212:215], v[192:207]
    ds_write_b64 v29, v[40:41] offset:4216
    s_nop 2
    v_max_f32 v176, 0, v176
    v_max_f32 v177, 0, v177
    v_max_f32 v178, 0, v178
    v_max_f32 v179, 0, v179
    v_max_f32 v180, 0, v180
    v_max_f32 v181, 0, v181
    v_mfma_f32_32x32x16_bf16 v[192:207], a[0:3], a[216:219], v[192:207]
    ds_write_b64 v29, v[42:43] offset:4224
    v_max_f32 v182, 0, v182
    v_max_f32 v183, 0, v183
    v_mul_f32 v176, v176, v184
    v_mul_f32 v177, v177, v185
    v_mul_f32 v178, v178, v186
    v_mfma_f32_32x32x16_bf16 v[192:207], a[4:7], a[220:223], v[192:207]
    v_mul_f32 v179, v179, v187
    v_mul_f32 v180, v180, v188
    v_mul_f32 v181, v181, v189
    v_mul_f32 v182, v182, v190
    v_mul_f32 v183, v183, v191
    v_cvt_pk_bf16_f32 v184, v176, v177
    v_cvt_pk_bf16_f32 v185, v178, v179
    v_mfma_f32_32x32x16_bf16 v[192:207], v[104:107], v[110:113], v[192:207]
    s_waitcnt vmcnt(11)
    ds_write_b128 v29, v[44:47] offset:1024
    v_cvt_pk_bf16_f32 v186, v180, v181
    v_cvt_pk_bf16_f32 v187, v182, v183
    buffer_store_dwordx4 v[184:187], v33, s[76:79], s43 offen offset:3072 sc1
    v_mfma_f32_32x32x16_bf16 v[208:223], a[8:11], a[208:211], v[208:223]
    ds_write_b64 v29, v[44:45] offset:5240
    v_mfma_f32_32x32x16_bf16 v[208:223], a[12:15], a[212:215], v[208:223]
    ds_write_b64 v29, v[46:47] offset:5248
    s_nop 2
    v_max_f32 v192, 0, v192
    v_max_f32 v193, 0, v193
    v_max_f32 v194, 0, v194
    v_max_f32 v195, 0, v195
    v_max_f32 v196, 0, v196
    v_max_f32 v197, 0, v197
    v_mfma_f32_32x32x16_bf16 v[208:223], a[16:19], a[216:219], v[208:223]
    v_max_f32 v198, 0, v198
    v_max_f32 v199, 0, v199
    v_mul_f32 v192, v192, v200
    v_mul_f32 v193, v193, v201
    v_mul_f32 v194, v194, v202
    v_mul_f32 v195, v195, v203
    v_mfma_f32_32x32x16_bf16 v[208:223], a[20:23], a[220:223], v[208:223]
    v_mul_f32 v196, v196, v204
    v_mul_f32 v197, v197, v205
    v_mul_f32 v198, v198, v206
    v_mul_f32 v199, v199, v207
    v_cvt_pk_bf16_f32 v200, v192, v193
    v_cvt_pk_bf16_f32 v201, v194, v195
    v_cvt_pk_bf16_f32 v202, v196, v197
    v_mfma_f32_32x32x16_bf16 v[208:223], v[104:107], v[116:119], v[208:223]
    v_cvt_pk_bf16_f32 v203, v198, v199
    buffer_store_dwordx4 v[200:203], v33, s[76:79], s11 offen offset:0 sc1
    v_mfma_f32_32x32x16_bf16 v[224:239], a[24:27], a[208:211], v[224:239]
    s_waitcnt lgkmcnt(0)
    s_barrier
    v_mfma_f32_32x32x16_bf16 v[224:239], a[28:31], a[212:215], v[224:239]
    s_nop 5
    v_max_f32 v208, 0, v208
    v_max_f32 v209, 0, v209
    v_max_f32 v210, 0, v210
    v_max_f32 v211, 0, v211
    v_max_f32 v212, 0, v212
    v_max_f32 v213, 0, v213
    v_max_f32 v214, 0, v214
    v_mfma_f32_32x32x16_bf16 v[224:239], a[32:35], a[216:219], v[224:239]
    v_max_f32 v215, 0, v215
    v_mul_f32 v208, v208, v216
    v_mul_f32 v209, v209, v217
    v_mul_f32 v210, v210, v218
    v_mul_f32 v211, v211, v219
    v_mul_f32 v212, v212, v220
    v_mfma_f32_32x32x16_bf16 v[224:239], a[36:39], a[220:223], v[224:239]
    v_mul_f32 v213, v213, v221
    v_mul_f32 v214, v214, v222
    v_mul_f32 v215, v215, v223
    v_cvt_pk_bf16_f32 v216, v208, v209
    v_cvt_pk_bf16_f32 v217, v210, v211
    v_cvt_pk_bf16_f32 v218, v212, v213
    v_cvt_pk_bf16_f32 v219, v214, v215
    v_mfma_f32_32x32x16_bf16 v[224:239], v[104:107], v[108:111], v[224:239]
    buffer_store_dwordx4 v[216:219], v33, s[76:79], s11 offen offset:1024 sc1
    v_mfma_f32_32x32x16_bf16 v[240:255], a[40:43], a[208:211], v[240:255]
    v_mfma_f32_32x32x16_bf16 v[240:255], a[44:47], a[212:215], v[240:255]
    s_nop 8
    v_max_f32 v224, 0, v224
    v_max_f32 v225, 0, v225
    v_max_f32 v226, 0, v226
    v_max_f32 v227, 0, v227
    v_max_f32 v228, 0, v228
    v_max_f32 v229, 0, v229
    v_max_f32 v230, 0, v230
    v_mfma_f32_32x32x16_bf16 v[240:255], a[48:51], a[216:219], v[240:255]
    v_max_f32 v231, 0, v231
    v_mul_f32 v224, v224, v232
    v_mul_f32 v225, v225, v233
    v_mul_f32 v226, v226, v234
    v_mul_f32 v227, v227, v235
    v_mul_f32 v228, v228, v236
    v_mfma_f32_32x32x16_bf16 v[240:255], a[52:55], a[220:223], v[240:255]
    v_mul_f32 v229, v229, v237
    v_mul_f32 v230, v230, v238
    v_mul_f32 v231, v231, v239
    v_cvt_pk_bf16_f32 v232, v224, v225
    v_cvt_pk_bf16_f32 v233, v226, v227
    v_cvt_pk_bf16_f32 v234, v228, v229
    v_cvt_pk_bf16_f32 v235, v230, v231
    v_mfma_f32_32x32x16_bf16 v[240:255], v[104:107], v[114:117], v[240:255]
    buffer_store_dwordx4 v[232:235], v33, s[76:79], s11 offen offset:2048 sc1
    v_accvgpr_read_b32 v1, a243
    v_accvgpr_read_b32 v2, a244
    v_accvgpr_read_b32 v3, a245
    v_accvgpr_read_b32 v4, a246
    v_accvgpr_read_b32 v5, a247
    v_accvgpr_read_b32 v35, a248
    v_accvgpr_read_b32 v28, a249
    v_accvgpr_read_b32 v29, a224
    ds_read_b128 v[64:67], v1 offset:192
    ds_read_b128 v[96:99], v2 offset:3776
    ds_read_b128 v[68:71], v1 offset:704
    ds_read_b128 v[100:103], v2 offset:3264
    ds_read_b128 v[72:75], v1 offset:1216
    ds_read_b128 v[104:107], v2 offset:2752
    ds_read_b128 v[76:79], v1 offset:1728
    ds_read_b128 v[108:111], v2 offset:2240
    ds_read_b128 v[80:83], v1 offset:2240
    ds_read_b128 v[112:115], v2 offset:1728
    ds_read_b128 v[84:87], v1 offset:2752
    ds_read_b128 v[116:119], v2 offset:1216
    ds_read_b128 v[88:91], v1 offset:3264
    ds_read_b128 v[120:123], v2 offset:704
    ds_read_b128 v[92:95], v1 offset:3776
    ds_read_b128 v[124:127], v2 offset:192
    v_max_f32 v240, 0, v240
    v_max_f32 v241, 0, v241
    v_max_f32 v242, 0, v242
    v_max_f32 v243, 0, v243
    v_max_f32 v244, 0, v244
    v_max_f32 v245, 0, v245
    v_max_f32 v246, 0, v246
    v_max_f32 v247, 0, v247
    v_pk_mul_f32 v[240:241], v[240:241], v[248:249]
    v_pk_mul_f32 v[242:243], v[242:243], v[250:251]
    v_pk_mul_f32 v[244:245], v[244:245], v[252:253]
    v_pk_mul_f32 v[246:247], v[246:247], v[254:255]
    v_cvt_pk_bf16_f32 v248, v240, v241
    v_cvt_pk_bf16_f32 v249, v242, v243
    v_cvt_pk_bf16_f32 v250, v244, v245
    v_cvt_pk_bf16_f32 v251, v246, v247
    buffer_store_dwordx4 v[248:251], v33, s[76:79], s11 offen offset:3072 sc1
    s_waitcnt lgkmcnt(14)
    v_mfma_f32_16x16x32_bf16 v[8:11], v[64:67], v[96:99], 0
    v_mov_b32 v30, s12
    s_mov_b64 exec, 0xf
    buffer_load_dword v30, v28, s[76:79], 0 offen sc1
    s_mov_b64 exec, -1
    s_waitcnt lgkmcnt(12)
    v_mfma_f32_16x16x32_bf16 v[12:15], v[64:67], v[100:103], 0
    ds_read_b128 v[128:131], v1 offset:128
    v_mfma_f32_16x16x32_bf16 v[12:15], v[68:71], v[96:99], v[12:15]
    v_mfma_f32_16x16x32_bf16 v[16:19], v[68:71], v[100:103], 0
    ds_read_b128 v[160:163], v2 offset:3712
    s_waitcnt lgkmcnt(12)
    v_mfma_f32_16x16x32_bf16 v[16:19], v[64:67], v[104:107], v[16:19]
    ds_read_b64_tr_b16 a[120:121], v4 offset:0
    ds_read_b64_tr_b16 a[122:123], v4 offset:1024
    v_mfma_f32_16x16x32_bf16 v[16:19], v[72:75], v[96:99], v[16:19]
    ds_read_b128 v[132:135], v1 offset:640
    v_mfma_f32_16x16x32_bf16 v[20:23], v[68:71], v[104:107], 0
    ds_read_b64_tr_b16 a[124:125], v5 offset:0
    v_mfma_f32_16x16x32_bf16 v[20:23], v[72:75], v[100:103], v[20:23]
    ds_read_b128 v[164:167], v2 offset:3200
    ds_read_b64_tr_b16 a[126:127], v5 offset:1024
    v_mfma_f32_16x16x32_bf16 v[48:51], v[72:75], v[104:107], 0
    ds_read_b64_tr_b16 a[128:129], v4 offset:2048
    s_waitcnt lgkmcnt(15)
    v_mfma_f32_16x16x32_bf16 v[20:23], v[64:67], v[108:111], v[20:23]
    ds_read_b128 v[136:139], v1 offset:1152
    v_mfma_f32_16x16x32_bf16 v[20:23], v[76:79], v[96:99], v[20:23]
    ds_read_b64_tr_b16 a[130:131], v4 offset:3072
    ds_read_b64_tr_b16 a[132:133], v5 offset:2048
    v_mfma_f32_16x16x32_bf16 v[48:51], v[68:71], v[108:111], v[48:51]
    ds_read_b128 v[168:171], v2 offset:2688
    v_mfma_f32_16x16x32_bf16 v[48:51], v[76:79], v[100:103], v[48:51]
    ds_read_b64_tr_b16 a[134:135], v5 offset:3072
    v_mfma_f32_16x16x32_bf16 v[52:55], v[72:75], v[108:111], 0
    ds_read_b128 v[140:143], v1 offset:1664
    v_mfma_f32_16x16x32_bf16 v[52:55], v[76:79], v[104:107], v[52:55]
    ds_read_b64_tr_b16 a[136:137], v4 offset:4096
    ds_read_b64_tr_b16 a[138:139], v4 offset:5120
    v_mfma_f32_16x16x32_bf16 v[56:59], v[76:79], v[108:111], 0
    ds_read_b128 v[172:175], v2 offset:2176
    v_mfma_f32_16x16x32_bf16 v[48:51], v[64:67], v[112:115], v[48:51]
    s_waitcnt vmcnt(1)
    s_mov_b64 exec, 0x1
    buffer_store_dword v31, v32, s[76:79], s24 offen sc1
    s_mov_b64 exec, -1
    v_mfma_f32_16x16x32_bf16 v[48:51], v[80:83], v[96:99], v[48:51]
    ds_read_b128 v[144:147], v1 offset:2176
    v_mfma_f32_16x16x32_bf16 v[52:55], v[68:71], v[112:115], v[52:55]
    ds_read_b64_tr_b16 a[140:141], v5 offset:4096
    v_mfma_f32_16x16x32_bf16 v[52:55], v[80:83], v[100:103], v[52:55]
    ds_read_b128 v[176:179], v2 offset:1664
    v_mfma_f32_16x16x32_bf16 v[56:59], v[72:75], v[112:115], v[56:59]
    ds_read_b64_tr_b16 a[142:143], v5 offset:5120
    ds_read_b64_tr_b16 a[144:145], v4 offset:6144
    v_mfma_f32_16x16x32_bf16 v[56:59], v[80:83], v[104:107], v[56:59]
    ds_read_b128 v[148:151], v1 offset:2688
    v_mfma_f32_16x16x32_bf16 v[60:63], v[76:79], v[112:115], 0
    ds_read_b64_tr_b16 a[146:147], v4 offset:7168
    v_mfma_f32_16x16x32_bf16 v[60:63], v[80:83], v[108:111], v[60:63]
    ds_read_b128 v[180:183], v2 offset:1152
    ds_read_b64_tr_b16 a[148:149], v5 offset:6144
    s_waitcnt lgkmcnt(15)
    v_mfma_f32_16x16x32_bf16 v[52:55], v[64:67], v[116:119], v[52:55]
    ds_read_b64_tr_b16 a[150:151], v5 offset:7168
    v_mfma_f32_16x16x32_bf16 v[52:55], v[84:87], v[96:99], v[52:55]
    ds_read_b128 v[152:155], v1 offset:3200
    v_mfma_f32_16x16x32_bf16 v[56:59], v[68:71], v[116:119], v[56:59]
    s_add_u32 m0, s14, 16384
    s_nop 0
    buffer_load_dwordx4 v36, s[68:71], s40 offen offset:0 lds
    v_mfma_f32_16x16x32_bf16 v[56:59], v[84:87], v[100:103], v[56:59]
    ds_read_b128 v[184:187], v2 offset:640
    v_mfma_f32_16x16x32_bf16 v[60:63], v[72:75], v[116:119], v[60:63]
    buffer_load_dwordx4 v37, s[68:71], s40 offen offset:1024 lds
    v_mfma_f32_16x16x32_bf16 v[60:63], v[84:87], v[104:107], v[60:63]
    ds_read_b128 v[156:159], v1 offset:3712
    v_mfma_f32_16x16x32_bf16 v[56:59], v[64:67], v[120:123], v[56:59]
    s_add_u32 s40, s40, 16384
    s_add_u32 m0, s14, 18432
    s_nop 0
    buffer_load_dwordx4 v36, s[68:71], s40 offen offset:0 lds
    v_mfma_f32_16x16x32_bf16 v[56:59], v[88:91], v[96:99], v[56:59]
    ds_read_b128 v[188:191], v2 offset:128
    v_mfma_f32_16x16x32_bf16 v[60:63], v[68:71], v[120:123], v[60:63]
    buffer_load_dwordx4 v37, s[68:71], s40 offen offset:1024 lds
    v_mfma_f32_16x16x32_bf16 v[60:63], v[88:91], v[100:103], v[60:63]
    v_mfma_f32_16x16x32_bf16 v[60:63], v[64:67], v[124:127], v[60:63]
    s_add_u32 s40, s40, 16384
    s_add_u32 m0, s14, 20480
    s_nop 0
    buffer_load_dwordx4 v36, s[68:71], s40 offen offset:0 lds
    v_mfma_f32_16x16x32_bf16 v[60:63], v[92:95], v[96:99], v[60:63]
    buffer_load_dwordx4 v37, s[68:71], s40 offen offset:1024 lds
    v_mfma_f32_16x16x32_bf16 v[8:11], v[128:131], v[160:163], v[8:11]
    v_mfma_f32_16x16x32_bf16 v[12:15], v[128:131], v[164:167], v[12:15]
    ds_read_b128 v[64:67], v1 offset:64
    v_mfma_f32_16x16x32_bf16 v[12:15], v[132:135], v[160:163], v[12:15]
    s_add_u32 s40, s40, 16384
    s_add_u32 m0, s14, 22528
    s_nop 0
    buffer_load_dwordx4 v36, s[68:71], s40 offen offset:0 lds
    v_mfma_f32_16x16x32_bf16 v[16:19], v[132:135], v[164:167], v[16:19]
    ds_read_b128 v[96:99], v2 offset:3648
    s_waitcnt lgkmcnt(15)
    v_mfma_f32_16x16x32_bf16 v[16:19], v[128:131], v[168:171], v[16:19]
    v_mfma_f32_16x16x32_bf16 v[16:19], v[136:139], v[160:163], v[16:19]
    ds_read_b128 v[68:71], v1 offset:576
    v_mfma_f32_16x16x32_bf16 v[20:23], v[132:135], v[168:171], v[20:23]
    buffer_load_dwordx4 v37, s[68:71], s40 offen offset:1024 lds
    s_add_u32 s40, s40, 16384
    v_mfma_f32_16x16x32_bf16 v[20:23], v[136:139], v[164:167], v[20:23]
    ds_read_b128 v[100:103], v2 offset:3136
    v_mfma_f32_16x16x32_bf16 v[48:51], v[136:139], v[168:171], v[48:51]
    v_mfma_f32_16x16x32_bf16 v[20:23], v[128:131], v[172:175], v[20:23]
    ds_read_b128 v[72:75], v1 offset:1088
    ds_read_b64_tr_b16 a[152:153], v4 offset:8192
    v_mfma_f32_16x16x32_bf16 v[20:23], v[140:143], v[160:163], v[20:23]
    ds_read_b64_tr_b16 a[154:155], v4 offset:9216
    v_mfma_f32_16x16x32_bf16 v[48:51], v[132:135], v[172:175], v[48:51]
    ds_read_b128 v[104:107], v2 offset:2624
    v_mfma_f32_16x16x32_bf16 v[48:51], v[140:143], v[164:167], v[48:51]
    s_waitcnt vmcnt(9)
    v_cmp_ne_u32 vcc, s12, v30
    s_nop 1
    s_cbranch_vccnz L_slow3
L_back3:
    s_add_u32 s11, s29, 32768
    buffer_load_dwordx4 a[240:243], v29, s[44:47], s29 offen
    v_mfma_f32_16x16x32_bf16 v[52:55], v[136:139], v[172:175], v[52:55]
    ds_read_b128 v[76:79], v1 offset:1600
    v_mfma_f32_16x16x32_bf16 v[52:55], v[140:143], v[168:171], v[52:55]
    ds_read_b64_tr_b16 a[156:157], v5 offset:8192
    v_mfma_f32_16x16x32_bf16 v[56:59], v[140:143], v[172:175], v[56:59]
    ds_read_b128 v[108:111], v2 offset:2112
    s_waitcnt lgkmcnt(15)
    v_mfma_f32_16x16x32_bf16 v[48:51], v[128:131], v[176:179], v[48:51]
    buffer_load_dwordx4 a[244:247], v29, s[44:47], s11 offen
    ds_read_b64_tr_b16 a[158:159], v5 offset:9216
    v_mfma_f32_16x16x32_bf16 v[48:51], v[144:147], v[160:163], v[48:51]
    ds_read_b128 v[80:83], v1 offset:2112
    v_mfma_f32_16x16x32_bf16 v[52:55], v[132:135], v[176:179], v[52:55]
    ds_read_b64_tr_b16 a[160:161], v4 offset:10240
    v_mfma_f32_16x16x32_bf16 v[52:55], v[144:147], v[164:167], v[52:55]
    ds_read_b128 v[112:115], v2 offset:1600
    ds_read_b64_tr_b16 a[162:163], v4 offset:11264
    v_mfma_f32_16x16x32_bf16 v[56:59], v[136:139], v[176:179], v[56:59]
    v_lshrrev_b32 v28, 3, v0
    v_lshlrev_b32 v28, 4, v28
    buffer_load_dwordx4 a[248:251], v28, s[76:79], s30 offen sc1
    v_mfma_f32_16x16x32_bf16 v[56:59], v[144:147], v[168:171], v[56:59]
    ds_read_b128 v[84:87], v1 offset:2624
    v_mfma_f32_16x16x32_bf16 v[60:63], v[140:143], v[176:179], v[60:63]
    ds_read_b64_tr_b16 a[164:165], v5 offset:10240
    v_mfma_f32_16x16x32_bf16 v[60:63], v[144:147], v[172:175], v[60:63]
    ds_read_b128 v[116:119], v2 offset:1088
    v_mfma_f32_16x16x32_bf16 v[52:55], v[128:131], v[180:183], v[52:55]
    buffer_load_dwordx4 a[252:255], v28, s[76:79], s30 offen offset:512 sc1
    ds_read_b64_tr_b16 a[166:167], v5 offset:11264
    v_mfma_f32_16x16x32_bf16 v[52:55], v[148:151], v[160:163], v[52:55]
    ds_read_b128 v[88:91], v1 offset:3136
    v_mfma_f32_16x16x32_bf16 v[56:59], v[132:135], v[180:183], v[56:59]
    ds_read_b64_tr_b16 a[168:169], v4 offset:12288
    v_mfma_f32_16x16x32_bf16 v[56:59], v[148:151], v[164:167], v[56:59]
    ds_read_b128 v[120:123], v2 offset:576
    ds_read_b64_tr_b16 a[170:171], v4 offset:13312
    v_mfma_f32_16x16x32_bf16 v[60:63], v[136:139], v[180:183], v[60:63]
    ds_read_b64_tr_b16 a[172:173], v5 offset:12288
    v_mfma_f32_16x16x32_bf16 v[60:63], v[148:151], v[168:171], v[60:63]
    ds_read_b128 v[92:95], v1 offset:3648
    s_waitcnt lgkmcnt(15)
    v_mfma_f32_16x16x32_bf16 v[56:59], v[128:131], v[184:187], v[56:59]
    ds_read_b64_tr_b16 a[174:175], v5 offset:13312
    ds_read_b64_tr_b16 a[176:177], v4 offset:14336
    v_mfma_f32_16x16x32_bf16 v[56:59], v[152:155], v[160:163], v[56:59]
    ds_read_b128 v[124:127], v2 offset:64
    v_mfma_f32_16x16x32_bf16 v[60:63], v[132:135], v[184:187], v[60:63]
    ds_read_b64_tr_b16 a[178:179], v4 offset:15360
    v_mfma_f32_16x16x32_bf16 v[60:63], v[152:155], v[164:167], v[60:63]
    ds_read_b64_tr_b16 a[180:181], v5 offset:14336
    v_mfma_f32_16x16x32_bf16 v[60:63], v[128:131], v[188:191], v[60:63]
    ds_read_b64_tr_b16 a[182:183], v5 offset:15360
    v_mfma_f32_16x16x32_bf16 v[60:63], v[156:159], v[160:163], v[60:63]
    v_mfma_f32_16x16x32_bf16 v[8:11], v[64:67], v[96:99], v[8:11]
    v_mfma_f32_16x16x32_bf16 v[12:15], v[64:67], v[100:103], v[12:15]
    ds_read_b128 v[128:131], v1 offset:0
    v_mfma_f32_16x16x32_bf16 v[12:15], v[68:71], v[96:99], v[12:15]
    v_mfma_f32_16x16x32_bf16 v[16:19], v[68:71], v[100:103], v[16:19]
    ds_read_b128 v[160:163], v2 offset:3584
    v_mfma_f32_16x16x32_bf16 v[16:19], v[64:67], v[104:107], v[16:19]
    s_add_u32 m0, s14, 0
    s_nop 0
    buffer_load_dwordx4 v36, s[68:71], s40 offen offset:0 lds
    v_mfma_f32_16x16x32_bf16 v[16:19], v[72:75], v[96:99], v[16:19]
    ds_read_b128 v[132:135], v1 offset:512
    v_mfma_f32_16x16x32_bf16 v[20:23], v[68:71], v[104:107], v[20:23]
    buffer_load_dwordx4 v37, s[68:71], s40 offen offset:1024 lds
    v_mfma_f32_16x16x32_bf16 v[20:23], v[72:75], v[100:103], v[20:23]
    ds_read_b128 v[164:167], v2 offset:3072
    v_mfma_f32_16x16x32_bf16 v[48:51], v[72:75], v[104:107], v[48:51]
    s_add_u32 s40, s40, 16384
    s_add_u32 m0, s14, 2048
    s_nop 0
    buffer_load_dwordx4 v36, s[68:71], s40 offen offset:0 lds
    v_mfma_f32_16x16x32_bf16 v[20:23], v[64:67], v[108:111], v[20:23]
    ds_read_b128 v[136:139], v1 offset:1024
    v_mfma_f32_16x16x32_bf16 v[20:23], v[76:79], v[96:99], v[20:23]
    buffer_load_dwordx4 v37, s[68:71], s40 offen offset:1024 lds
    v_mfma_f32_16x16x32_bf16 v[48:51], v[68:71], v[108:111], v[48:51]
    ds_read_b128 v[168:171], v2 offset:2560
    v_mfma_f32_16x16x32_bf16 v[48:51], v[76:79], v[100:103], v[48:51]
    s_add_u32 s40, s40, 16384
    s_add_u32 m0, s14, 4096
    s_nop 0
    buffer_load_dwordx4 v36, s[68:71], s40 offen offset:0 lds
    v_mfma_f32_16x16x32_bf16 v[52:55], v[72:75], v[108:111], v[52:55]
    ds_read_b128 v[140:143], v1 offset:1536
    v_mfma_f32_16x16x32_bf16 v[52:55], v[76:79], v[104:107], v[52:55]
    buffer_load_dwordx4 v37, s[68:71], s40 offen offset:1024 lds
    v_mfma_f32_16x16x32_bf16 v[56:59], v[76:79], v[108:111], v[56:59]
    ds_read_b128 v[172:175], v2 offset:2048
    s_waitcnt lgkmcnt(15)
    v_mfma_f32_16x16x32_bf16 v[48:51], v[64:67], v[112:115], v[48:51]
    s_add_u32 s40, s40, 16384
    s_add_u32 m0, s14, 6144
    s_nop 0
    buffer_load_dwordx4 v36, s[68:71], s40 offen offset:0 lds
    v_mfma_f32_16x16x32_bf16 v[48:51], v[80:83], v[96:99], v[48:51]
    ds_read_b128 v[144:147], v1 offset:2048
    v_mfma_f32_16x16x32_bf16 v[52:55], v[68:71], v[112:115], v[52:55]
    s_lshl_b32 s10, s3, 12
    v_mfma_f32_16x16x32_bf16 v[52:55], v[80:83], v[100:103], v[52:55]
    ds_read_b128 v[176:179], v2 offset:1536
    v_mfma_f32_16x16x32_bf16 v[56:59], v[72:75], v[112:115], v[56:59]
    s_add_u32 s10, s10, 98816
    v_add_u32 v7, s10, v33
    v_mfma_f32_16x16x32_bf16 v[56:59], v[80:83], v[104:107], v[56:59]
    ds_read_b128 v[148:151], v1 offset:2560
    v_mfma_f32_16x16x32_bf16 v[60:63], v[76:79], v[112:115], v[60:63]
    v_lshlrev_b32 v6, 3, v0
    v_mfma_f32_16x16x32_bf16 v[60:63], v[80:83], v[108:111], v[60:63]
    ds_read_b128 v[180:183], v2 offset:1024
    ds_read_b64 v[40:41], v3 offset:1536
    v_mfma_f32_16x16x32_bf16 v[52:55], v[64:67], v[116:119], v[52:55]
    ds_read_b64 v[42:43], v3 offset:1024
    v_mfma_f32_16x16x32_bf16 v[52:55], v[84:87], v[96:99], v[52:55]
    ds_read_b128 v[152:155], v1 offset:3072
    v_mfma_f32_16x16x32_bf16 v[56:59], v[68:71], v[116:119], v[56:59]
    ds_read_b64 v[44:45], v3 offset:512
    ds_read_b64 v[46:47], v3 offset:0
    v_mfma_f32_16x16x32_bf16 v[56:59], v[84:87], v[100:103], v[56:59]
    ds_read_b128 v[184:187], v2 offset:512
    v_mfma_f32_16x16x32_bf16 v[60:63], v[72:75], v[116:119], v[60:63]
    v_mfma_f32_16x16x32_bf16 v[60:63], v[84:87], v[104:107], v[60:63]
    ds_read_b128 v[156:159], v1 offset:3584
    v_mfma_f32_16x16x32_bf16 v[56:59], v[64:67], v[120:123], v[56:59]
    buffer_load_dwordx4 v37, s[68:71], s40 offen offset:1024 lds
    s_add_u32 s40, s40, 16384
    v_mfma_f32_16x16x32_bf16 v[56:59], v[88:91], v[96:99], v[56:59]
    ds_read_b128 v[188:191], v2 offset:0
    v_mfma_f32_16x16x32_bf16 v[60:63], v[68:71], v[120:123], v[60:63]
    v_mfma_f32_16x16x32_bf16 v[60:63], v[88:91], v[100:103], v[60:63]
    s_waitcnt lgkmcnt(15)
    s_add_u32 m0, s14, 8192
    s_nop 0
    buffer_load_dwordx4 v36, s[68:71], s40 offen offset:0 lds
    v_mfma_f32_16x16x32_bf16 v[60:63], v[64:67], v[124:127], v[60:63]
    buffer_load_dwordx4 v37, s[68:71], s40 offen offset:1024 lds
    v_mfma_f32_16x16x32_bf16 v[60:63], v[92:95], v[96:99], v[60:63]
    v_mfma_f32_16x16x32_bf16 v[8:11], v[128:131], v[160:163], v[8:11]
    v_mfma_f32_16x16x32_bf16 v[12:15], v[128:131], v[164:167], v[12:15]
    s_add_u32 s40, s40, 16384
    s_add_u32 m0, s14, 10240
    s_nop 0
    buffer_load_dwordx4 v36, s[68:71], s40 offen offset:0 lds
    v_mfma_f32_16x16x32_bf16 v[12:15], v[132:135], v[160:163], v[12:15]
    buffer_load_dwordx4 v37, s[68:71], s40 offen offset:1024 lds
    v_mfma_f32_16x16x32_bf16 v[16:19], v[132:135], v[164:167], v[16:19]
    s_waitcnt lgkmcnt(14)
    v_mfma_f32_16x16x32_bf16 v[16:19], v[128:131], v[168:171], v[16:19]
    s_waitcnt lgkmcnt(0)
    s_barrier
    v_mfma_f32_16x16x32_bf16 v[16:19], v[136:139], v[160:163], v[16:19]
    v_mfma_f32_16x16x32_bf16 v[20:23], v[132:135], v[168:171], v[20:23]
    v_mfma_f32_16x16x32_bf16 v[20:23], v[136:139], v[164:167], v[20:23]
    v_mfma_f32_16x16x32_bf16 v[48:51], v[136:139], v[168:171], v[48:51]
    s_add_u32 s40, s40, 16384
    s_add_u32 m0, s14, 12288
    s_nop 0
    buffer_load_dwordx4 v36, s[68:71], s40 offen offset:0 lds
    v_mfma_f32_16x16x32_bf16 v[20:23], v[128:131], v[172:175], v[20:23]
    buffer_load_dwordx4 v37, s[68:71], s40 offen offset:1024 lds
    v_mfma_f32_16x16x32_bf16 v[20:23], v[140:143], v[160:163], v[20:23]
    v_mfma_f32_16x16x32_bf16 v[48:51], v[132:135], v[172:175], v[48:51]
    v_mfma_f32_16x16x32_bf16 v[48:51], v[140:143], v[164:167], v[48:51]
    s_add_u32 s40, s40, 16384
    s_add_u32 m0, s14, 14336
    s_nop 0
    buffer_load_dwordx4 v36, s[68:71], s40 offen offset:0 lds
    v_mfma_f32_16x16x32_bf16 v[52:55], v[136:139], v[172:175], v[52:55]
    v_mfma_f32_16x16x32_bf16 v[52:55], v[140:143], v[168:171], v[52:55]
    v_mfma_f32_16x16x32_bf16 v[56:59], v[140:143], v[172:175], v[56:59]
    v_mfma_f32_16x16x32_bf16 v[48:51], v[128:131], v[176:179], v[48:51]
    buffer_load_dwordx4 v37, s[68:71], s40 offen offset:1024 lds
    s_add_u32 s40, s40, 16384
    v_mfma_f32_16x16x32_bf16 v[48:51], v[144:147], v[160:163], v[48:51]
    s_waitcnt vmcnt(20)
    v_mfma_f32_16x16x32_bf16 v[52:55], v[132:135], v[176:179], v[52:55]
    ds_read_b64_tr_b16 a[184:185], v4 offset:16384
    v_mfma_f32_16x16x32_bf16 v[52:55], v[144:147], v[164:167], v[52:55]
    ds_read_b64_tr_b16 a[186:187], v4 offset:17408
    ds_read_b64_tr_b16 a[188:189], v5 offset:16384
    v_mfma_f32_16x16x32_bf16 v[56:59], v[136:139], v[176:179], v[56:59]
    ds_read_b64_tr_b16 a[190:191], v5 offset:17408
    v_mfma_f32_16x16x32_bf16 v[56:59], v[144:147], v[168:171], v[56:59]
    ds_read_b64_tr_b16 a[192:193], v4 offset:18432
    v_mfma_f32_16x16x32_bf16 v[60:63], v[140:143], v[176:179], v[60:63]
    ds_read_b64_tr_b16 a[194:195], v4 offset:19456
    ds_read_b64_tr_b16 a[196:197], v5 offset:18432
    v_mfma_f32_16x16x32_bf16 v[60:63], v[144:147], v[172:175], v[60:63]
    ds_read_b64_tr_b16 a[198:199], v5 offset:19456
    v_mfma_f32_16x16x32_bf16 v[52:55], v[128:131], v[180:183], v[52:55]
    ds_read_b64_tr_b16 a[200:201], v4 offset:20480
    v_mfma_f32_16x16x32_bf16 v[52:55], v[148:151], v[160:163], v[52:55]
    ds_read_b64_tr_b16 a[202:203], v4 offset:21504
    v_mfma_f32_16x16x32_bf16 v[56:59], v[132:135], v[180:183], v[56:59]
    ds_read_b64_tr_b16 a[204:205], v5 offset:20480
    ds_read_b64_tr_b16 a[206:207], v5 offset:21504
    v_mfma_f32_16x16x32_bf16 v[56:59], v[148:151], v[164:167], v[56:59]
    ds_read_b64_tr_b16 a[208:209], v4 offset:22528
    v_mfma_f32_16x16x32_bf16 v[60:63], v[136:139], v[180:183], v[60:63]
    ds_read_b64_tr_b16 a[210:211], v4 offset:23552
    v_mfma_f32_16x16x32_bf16 v[60:63], v[148:151], v[168:171], v[60:63]
    ds_read_b64_tr_b16 a[212:213], v5 offset:22528
    ds_read_b64_tr_b16 a[214:215], v5 offset:23552
    v_mfma_f32_16x16x32_bf16 v[56:59], v[128:131], v[184:187], v[56:59]
    s_waitcnt vmcnt(8)
    v_mfma_f32_16x16x32_bf16 v[56:59], v[152:155], v[160:163], v[56:59]
    ds_read_b64_tr_b16 a[216:217], v4 offset:0
    v_mfma_f32_16x16x32_bf16 v[60:63], v[132:135], v[184:187], v[60:63]
    v_mov_b32 v34, s12
    s_mov_b64 exec, 0xff
    buffer_load_dword v34, v35, s[76:79], s86 offen sc1
    s_mov_b64 exec, -1
    v_mfma_f32_16x16x32_bf16 v[60:63], v[152:155], v[164:167], v[60:63]
    ds_read_b64_tr_b16 a[218:219], v4 offset:1024
    v_mfma_f32_16x16x32_bf16 v[60:63], v[128:131], v[188:191], v[60:63]
    ds_read_b64_tr_b16 a[220:221], v5 offset:0
    v_mfma_f32_16x16x32_bf16 v[60:63], v[156:159], v[160:163], v[60:63]
    ds_read_b64_tr_b16 a[222:223], v5 offset:1024
    s_waitcnt lgkmcnt(4)
    s_add_u32 m0, s14, 16384
    s_nop 0
    buffer_load_dwordx4 v36, s[68:71], s40 offen offset:0 lds
    buffer_load_dwordx4 v37, s[68:71], s40 offen offset:1024 lds
    s_add_u32 s40, s40, 16384
    s_add_u32 m0, s14, 18432
    s_nop 0
    buffer_load_dwordx4 v36, s[68:71], s40 offen offset:0 lds
    buffer_load_dwordx4 v37, s[68:71], s40 offen offset:1024 lds
    s_bitcmp1_b32 s3, 0
    s_cbranch_scc1 L_xBm
    ds_write_b128 v7, v[48:51] offset:0
    ds_write_b128 v7, v[52:55] offset:1024
    ds_write_b128 v7, v[56:59] offset:2048
    ds_write_b128 v7, v[60:63] offset:3072
    s_branch L_xEm
L_xBm:
    ds_write_b128 v7, v[8:11] offset:0
    ds_write_b128 v7, v[12:15] offset:1024
    ds_write_b128 v7, v[16:19] offset:2048
    ds_write_b128 v7, v[20:23] offset:3072
    v_mov_b32 v8, v48
    v_mov_b32 v9, v49
    v_mov_b32 v10, v50
    v_mov_b32 v11, v51
    v_mov_b32 v12, v52
    v_mov_b32 v13, v53
    v_mov_b32 v14, v54
    v_mov_b32 v15, v55
    v_mov_b32 v16, v56
    v_mov_b32 v17, v57
    v_mov_b32 v18, v58
    v_mov_b32 v19, v59
    v_mov_b32 v20, v60
    v_mov_b32 v21, v61
    v_mov_b32 v22, v62
    v_mov_b32 v23, v63
L_xEm:
    v_xor_b32 v7, 0x1000, v7
    v_and_b32 v24, s15, v41
    v_lshlrev_b32 v25, 16, v41
    v_and_b32 v26, s15, v40
    v_lshlrev_b32 v27, 16, v40
    v_fma_f32 v8, s13, v24, v8
    v_fma_f32 v9, s13, v25, v9
    v_fma_f32 v10, s13, v26, v10
    v_fma_f32 v11, s13, v27, v11
    s_add_u32 s40, s40, 16384
    s_add_u32 m0, s14, 20480
    s_nop 0
    buffer_load_dwordx4 v36, s[68:71], s40 offen offset:0 lds
    v_and_b32 v24, s15, v43
    v_lshlrev_b32 v25, 16, v43
    v_and_b32 v26, s15, v42
    v_lshlrev_b32 v27, 16, v42
    v_fma_f32 v12, s13, v24, v12
    v_fma_f32 v13, s13, v25, v13
    v_fma_f32 v14, s13, v26, v14
    v_fma_f32 v15, s13, v27, v15
    buffer_load_dwordx4 v37, s[68:71], s40 offen offset:1024 lds
    v_and_b32 v24, s15, v45
    v_lshlrev_b32 v25, 16, v45
    v_and_b32 v26, s15, v44
    v_lshlrev_b32 v27, 16, v44
    v_fma_f32 v16, s13, v24, v16
    v_fma_f32 v17, s13, v25, v17
    v_fma_f32 v18, s13, v26, v18
    v_fma_f32 v19, s13, v27, v19
    s_add_u32 s40, s40, 16384
    s_add_u32 m0, s14, 22528
    s_nop 0
    buffer_load_dwordx4 v36, s[68:71], s40 offen offset:0 lds
    v_and_b32 v24, s15, v47
    v_lshlrev_b32 v25, 16, v47
    v_and_b32 v26, s15, v46
    v_lshlrev_b32 v27, 16, v46
    v_fma_f32 v20, s13, v24, v20
    v_fma_f32 v21, s13, v25, v21
    v_fma_f32 v22, s13, v26, v22
    v_fma_f32 v23, s13, v27, v23
    buffer_load_dwordx4 v37, s[68:71], s40 offen offset:1024 lds
    s_add_u32 s40, s40, 16384
    s_waitcnt lgkmcnt(0)
    s_barrier
    ds_read_b128 v[48:51], v7 offset:0
    ds_read_b128 v[52:55], v7 offset:1024
    ds_read_b128 v[56:59], v7 offset:2048
    ds_read_b128 v[60:63], v7 offset:3072
    s_add_u32 m0, s14, 0
    s_nop 0
    buffer_load_dwordx4 v36, s[68:71], s40 offen offset:0 lds
    buffer_load_dwordx4 v37, s[68:71], s40 offen offset:1024 lds
    s_add_u32 s40, s40, 16384
    s_waitcnt lgkmcnt(3)
    v_add_f32 v8, v8, v48
    v_add_f32 v9, v9, v49
    v_add_f32 v10, v10, v50
    v_add_f32 v11, v11, v51
    v_cvt_pk_bf16_f32 v40, v8, v9
    v_cvt_pk_bf16_f32 v41, v10, v11
    s_waitcnt lgkmcnt(2)
    v_add_f32 v12, v12, v52
    v_add_f32 v13, v13, v53
    v_add_f32 v14, v14, v54
    v_add_f32 v15, v15, v55
    v_cvt_pk_bf16_f32 v42, v12, v13
    v_cvt_pk_bf16_f32 v43, v14, v15
    s_waitcnt lgkmcnt(1)
    v_add_f32 v16, v16, v56
    v_add_f32 v17, v17, v57
    v_add_f32 v18, v18, v58
    v_add_f32 v19, v19, v59
    v_cvt_pk_bf16_f32 v44, v16, v17
    v_cvt_pk_bf16_f32 v45, v18, v19
    s_waitcnt lgkmcnt(0)
    v_add_f32 v20, v20, v60
    v_add_f32 v21, v21, v61
    v_add_f32 v22, v22, v62
    v_add_f32 v23, v23, v63
    v_cvt_pk_bf16_f32 v46, v20, v21
    v_cvt_pk_bf16_f32 v47, v22, v23
    buffer_store_dwordx2 v[40:41], v6, s[76:79], s0 offen offset:0 sc1
    buffer_store_dwordx2 v[42:43], v6, s[76:79], s0 offen offset:512 sc1
    buffer_store_dwordx2 v[44:45], v6, s[76:79], s0 offen offset:1024 sc1
    buffer_store_dwordx2 v[46:47], v6, s[76:79], s0 offen offset:1536 sc1
    s_waitcnt vmcnt(14)
    v_cmp_ne_u32 vcc, s12, v34
    s_nop 1
    s_cbranch_vccnz L_slow4
L_back4:
L_g2:
    buffer_load_dwordx4 v[192:195], v33, s[76:79], s25 offen offset:0 sc1
    buffer_load_dwordx4 v[196:199], v33, s[76:79], s25 offen offset:1024 sc1
    buffer_load_dwordx4 v[200:203], v33, s[76:79], s25 offen offset:2048 sc1
    buffer_load_dwordx4 v[204:207], v33, s[76:79], s25 offen offset:3072 sc1
    s_add_u32 s25, s25, 4096
    buffer_load_dwordx4 v[208:211], v33, s[76:79], s25 offen offset:0 sc1
    buffer_load_dwordx4 v[212:215], v33, s[76:79], s25 offen offset:1024 sc1
    v_accvgpr_read_b32 v8, a226
    v_accvgpr_read_b32 v9, a227
    v_accvgpr_read_b32 v11, a228
    v_accvgpr_read_b32 v7, a225
    v_accvgpr_read_b32 v1, a229
    v_accvgpr_read_b32 v2, a230
    v_accvgpr_read_b32 v3, a231
    ds_read_b64_tr_b16 a[0:1], v4 offset:2048
    ds_read_b64_tr_b16 a[2:3], v4 offset:3072
    ds_read_b64_tr_b16 a[4:5], v5 offset:2048
    ds_read_b64_tr_b16 a[6:7], v5 offset:3072
    ds_read_b64_tr_b16 a[8:9], v4 offset:4096
    buffer_load_dwordx4 v[216:219], v33, s[76:79], s25 offen offset:2048 sc1
    ds_read_b64_tr_b16 a[10:11], v4 offset:5120
    ds_read_b64_tr_b16 a[12:13], v5 offset:4096
    ds_read_b64_tr_b16 a[14:15], v5 offset:5120
    ds_read_b64_tr_b16 a[16:17], v4 offset:6144
    ds_read_b64_tr_b16 a[18:19], v4 offset:7168
    ds_read_b64_tr_b16 a[20:21], v5 offset:6144
    ds_read_b64_tr_b16 a[22:23], v5 offset:7168
    ds_read_b64_tr_b16 a[24:25], v4 offset:8192
    ds_read_b64_tr_b16 a[26:27], v4 offset:9216
    ds_read_b64_tr_b16 a[28:29], v5 offset:8192
    ds_read_b64_tr_b16 a[30:31], v5 offset:9216
    buffer_load_dwordx4 v[220:223], v33, s[76:79], s25 offen offset:3072 sc1
    s_add_u32 s25, s25, 4096
    ds_read_b64_tr_b16 a[32:33], v4 offset:10240
    ds_read_b64_tr_b16 a[34:35], v4 offset:11264
    ds_read_b64_tr_b16 a[36:37], v5 offset:10240
    ds_read_b64_tr_b16 a[38:39], v5 offset:11264
    ds_read_b64_tr_b16 a[40:41], v4 offset:12288
    ds_read_b64_tr_b16 a[42:43], v4 offset:13312
    ds_read_b64_tr_b16 a[44:45], v5 offset:12288
    ds_read_b64_tr_b16 a[46:47], v5 offset:13312
    ds_read_b64_tr_b16 a[48:49], v4 offset:14336
    ds_read_b64_tr_b16 a[50:51], v4 offset:15360
    ds_read_b64_tr_b16 a[52:53], v5 offset:14336
    ds_read_b64_tr_b16 a[54:55], v5 offset:15360
    buffer_load_dwordx4 v[224:227], v33, s[76:79], s25 offen offset:0 sc1
    v_add_u32 v10, 49408, v9
    v_and_b32 v35, 15, v0
    v_lshlrev_b32 v35, 7, v35
    v_accvgpr_read_b32 v16, a240
    v_accvgpr_read_b32 v17, a241
    v_accvgpr_read_b32 v18, a242
    v_accvgpr_read_b32 v19, a243
    v_accvgpr_read_b32 v20, a244
    v_accvgpr_read_b32 v21, a245
    v_accvgpr_read_b32 v22, a246
    v_accvgpr_read_b32 v23, a247
    v_accvgpr_read_b32 v24, a248
    buffer_load_dwordx4 v[228:231], v33, s[76:79], s25 offen offset:1024 sc1
    v_accvgpr_read_b32 v25, a249
    v_accvgpr_read_b32 v26, a250
    v_accvgpr_read_b32 v27, a251
    v_accvgpr_read_b32 v36, a252
    v_accvgpr_read_b32 v37, a253
    v_accvgpr_read_b32 v38, a254
    v_accvgpr_read_b32 v39, a255
    s_waitcnt vmcnt(9)
    v_mfma_f32_32x32x16_bf16 v[128:143], a[96:99], v[192:195], 0
    buffer_load_dwordx4 v[232:235], v33, s[76:79], s25 offen offset:2048 sc1
    s_mov_b64 exec, 0x1
    buffer_store_dword v31, v32, s[76:79], s1 offen sc1
    s_mov_b64 exec, -1
    v_mfma_f32_32x32x16_bf16 v[144:159], a[100:103], v[192:195], 0
    ds_read_b64_tr_b16 a[56:57], v4 offset:16384
    ds_read_b64_tr_b16 a[58:59], v4 offset:17408
    ds_read_b64_tr_b16 a[60:61], v5 offset:16384
    ds_read_b64_tr_b16 a[62:63], v5 offset:17408
    s_waitcnt vmcnt(10)
    v_mfma_f32_32x32x16_bf16 v[128:143], a[104:107], v[196:199], v[128:143]
    buffer_load_dwordx4 v[236:239], v33, s[76:79], s25 offen offset:3072 sc1
    s_add_u32 s25, s25, 4096
    ds_read_b64_tr_b16 a[64:65], v4 offset:18432
    ds_read_b64_tr_b16 a[66:67], v4 offset:19456
    ds_read_b64_tr_b16 a[68:69], v5 offset:18432
    v_mfma_f32_32x32x16_bf16 v[144:159], a[108:111], v[196:199], v[144:159]
    ds_read_b64_tr_b16 a[70:71], v5 offset:19456
    ds_read_b64_tr_b16 a[72:73], v4 offset:20480
    ds_read_b64_tr_b16 a[74:75], v4 offset:21504
    ds_read_b64_tr_b16 a[76:77], v5 offset:20480
    ds_read_b64_tr_b16 a[78:79], v5 offset:21504
    s_waitcnt vmcnt(10)
    v_mfma_f32_32x32x16_bf16 v[128:143], a[112:115], v[200:203], v[128:143]
    buffer_load_dwordx4 v[240:243], v33, s[76:79], s25 offen offset:0 sc1
    ds_read_b64_tr_b16 a[80:81], v4 offset:22528
    ds_read_b64_tr_b16 a[82:83], v4 offset:23552
    ds_read_b64_tr_b16 a[84:85], v5 offset:22528
    ds_read_b64_tr_b16 a[86:87], v5 offset:23552
    v_mfma_f32_32x32x16_bf16 v[144:159], a[116:119], v[200:203], v[144:159]
    ds_read_b64_tr_b16 a[88:89], v4 offset:0
    ds_read_b64_tr_b16 a[90:91], v4 offset:1024
    ds_read_b64_tr_b16 a[92:93], v5 offset:0
    ds_read_b64_tr_b16 a[94:95], v5 offset:1024
    s_waitcnt vmcnt(10)
    v_mfma_f32_32x32x16_bf16 v[128:143], a[120:123], v[204:207], v[128:143]
    buffer_load_dwordx4 v[244:247], v33, s[76:79], s25 offen offset:1024 sc1
    v_mfma_f32_32x32x16_bf16 v[144:159], a[124:127], v[204:207], v[144:159]
    s_waitcnt vmcnt(10)
    v_mfma_f32_32x32x16_bf16 v[128:143], a[128:131], v[208:211], v[128:143]
    buffer_load_dwordx4 v[248:251], v33, s[76:79], s25 offen offset:2048 sc1
    v_mfma_f32_32x32x16_bf16 v[144:159], a[132:135], v[208:211], v[144:159]
    s_waitcnt vmcnt(10)
    v_mfma_f32_32x32x16_bf16 v[128:143], a[136:139], v[212:215], v[128:143]
    buffer_load_dwordx4 v[252:255], v33, s[76:79], s25 offen offset:3072 sc1
    s_add_u32 s25, s25, 4096
    v_mfma_f32_32x32x16_bf16 v[144:159], a[140:143], v[212:215], v[144:159]
    s_waitcnt vmcnt(10)
    v_mfma_f32_32x32x16_bf16 v[128:143], a[144:147], v[216:219], v[128:143]
    buffer_load_dwordx4 v[64:67], v33, s[76:79], s25 offen offset:0 sc1
    v_mfma_f32_32x32x16_bf16 v[144:159], a[148:151], v[216:219], v[144:159]
    s_waitcnt vmcnt(10)
    v_mfma_f32_32x32x16_bf16 v[128:143], a[152:155], v[220:223], v[128:143]
    buffer_load_dwordx4 v[68:71], v33, s[76:79], s25 offen offset:1024 sc1
    v_mfma_f32_32x32x16_bf16 v[144:159], a[156:159], v[220:223], v[144:159]
    s_waitcnt vmcnt(10)
    v_mfma_f32_32x32x16_bf16 v[128:143], a[160:163], v[224:227], v[128:143]
    buffer_load_dwordx4 v[72:75], v33, s[76:79], s25 offen offset:2048 sc1
    v_mfma_f32_32x32x16_bf16 v[144:159], a[164:167], v[224:227], v[144:159]
    s_waitcnt vmcnt(10)
    v_mfma_f32_32x32x16_bf16 v[128:143], a[168:171], v[228:231], v[128:143]
    buffer_load_dwordx4 v[76:79], v33, s[76:79], s25 offen offset:3072 sc1
    s_add_u32 s25, s25, 4096
    v_mfma_f32_32x32x16_bf16 v[144:159], a[172:175], v[228:231], v[144:159]
    s_waitcnt vmcnt(10)
    v_mfma_f32_32x32x16_bf16 v[128:143], a[176:179], v[232:235], v[128:143]
    buffer_load_dwordx4 v[80:83], v33, s[76:79], s25 offen offset:0 sc1
    v_mfma_f32_32x32x16_bf16 v[144:159], a[180:183], v[232:235], v[144:159]
    s_waitcnt vmcnt(9)
    v_mfma_f32_32x32x16_bf16 v[128:143], a[184:187], v[236:239], v[128:143]
    buffer_load_dwordx4 v[84:87], v33, s[76:79], s25 offen offset:1024 sc1
    v_mfma_f32_32x32x16_bf16 v[144:159], a[188:191], v[236:239], v[144:159]
    s_waitcnt vmcnt(9)
    v_mfma_f32_32x32x16_bf16 v[128:143], a[192:195], v[240:243], v[128:143]
    buffer_load_dwordx4 v[88:91], v33, s[76:79], s25 offen offset:2048 sc1
    v_mfma_f32_32x32x16_bf16 v[144:159], a[196:199], v[240:243], v[144:159]
    s_waitcnt vmcnt(9)
    v_mfma_f32_32x32x16_bf16 v[128:143], a[200:203], v[244:247], v[128:143]
    buffer_load_dwordx4 v[92:95], v33, s[76:79], s25 offen offset:3072 sc1
    s_add_u32 s25, s25, 4096
    v_mfma_f32_32x32x16_bf16 v[144:159], a[204:207], v[244:247], v[144:159]
    s_waitcnt vmcnt(9)
    v_mfma_f32_32x32x16_bf16 v[128:143], a[208:211], v[248:251], v[128:143]
    buffer_load_dwordx4 v[96:99], v33, s[76:79], s25 offen offset:0 sc1
    v_mfma_f32_32x32x16_bf16 v[144:159], a[212:215], v[248:251], v[144:159]
    s_waitcnt vmcnt(9)
    v_mfma_f32_32x32x16_bf16 v[128:143], a[216:219], v[252:255], v[128:143]
    buffer_load_dwordx4 v[100:103], v33, s[76:79], s25 offen offset:1024 sc1
    v_mfma_f32_32x32x16_bf16 v[144:159], a[220:223], v[252:255], v[144:159]
    s_waitcnt vmcnt(9) lgkmcnt(15)
    v_mfma_f32_32x32x16_bf16 v[128:143], a[0:3], v[64:67], v[128:143]
    buffer_load_dwordx4 v[104:107], v33, s[76:79], s25 offen offset:2048 sc1
    v_mfma_f32_32x32x16_bf16 v[144:159], a[4:7], v[64:67], v[144:159]
    s_waitcnt vmcnt(9)
    v_mfma_f32_32x32x16_bf16 v[128:143], a[8:11], v[68:71], v[128:143]
    buffer_load_dwordx4 v[108:111], v33, s[76:79], s25 offen offset:3072 sc1
    s_add_u32 s25, s25, 90112
    v_mfma_f32_32x32x16_bf16 v[144:159], a[12:15], v[68:71], v[144:159]
    s_waitcnt vmcnt(9)
    v_mfma_f32_32x32x16_bf16 v[128:143], a[16:19], v[72:75], v[128:143]
    buffer_load_dwordx4 v[112:115], v33, s[76:79], s25 offen offset:0 sc1
    v_mfma_f32_32x32x16_bf16 v[144:159], a[20:23], v[72:75], v[144:159]
    s_waitcnt vmcnt(9)
    v_mfma_f32_32x32x16_bf16 v[128:143], a[24:27], v[76:79], v[128:143]
    buffer_load_dwordx4 v[116:119], v33, s[76:79], s25 offen offset:1024 sc1
    v_mfma_f32_32x32x16_bf16 v[144:159], a[28:31], v[76:79], v[144:159]
    s_waitcnt vmcnt(9)
    v_mfma_f32_32x32x16_bf16 v[128:143], a[32:35], v[80:83], v[128:143]
    buffer_load_dwordx4 v[120:123], v33, s[76:79], s25 offen offset:2048 sc1
    v_mov_b32 v34, s12
    s_mov_b64 exec, 0xffff
    buffer_load_dword v34, v35, s[76:79], s87 offen sc1
    s_mov_b64 exec, -1
    v_mfma_f32_32x32x16_bf16 v[144:159], a[36:39], v[80:83], v[144:159]
    s_waitcnt vmcnt(10)
    v_mfma_f32_32x32x16_bf16 v[128:143], a[40:43], v[84:87], v[128:143]
    buffer_load_dwordx4 v[124:127], v33, s[76:79], s25 offen offset:3072 sc1
    s_add_u32 s25, s25, 4096
    v_mfma_f32_32x32x16_bf16 v[144:159], a[44:47], v[84:87], v[144:159]
    s_waitcnt vmcnt(10)
    v_mfma_f32_32x32x16_bf16 v[128:143], a[48:51], v[88:91], v[128:143]
    buffer_load_dwordx4 v[48:51], v33, s[76:79], s25 offen offset:0 sc1
    v_mfma_f32_32x32x16_bf16 v[144:159], a[52:55], v[88:91], v[144:159]
    s_waitcnt vmcnt(10)
    v_mfma_f32_32x32x16_bf16 v[128:143], a[56:59], v[92:95], v[128:143]
    buffer_load_dwordx4 v[52:55], v33, s[76:79], s25 offen offset:1024 sc1
    v_mfma_f32_32x32x16_bf16 v[144:159], a[60:63], v[92:95], v[144:159]
    s_waitcnt vmcnt(10) lgkmcnt(14)
    v_mfma_f32_32x32x16_bf16 v[128:143], a[64:67], v[96:99], v[128:143]
    buffer_load_dwordx4 v[56:59], v33, s[76:79], s25 offen offset:2048 sc1
    s_waitcnt lgkmcnt(12)
    v_mfma_f32_32x32x16_bf16 v[144:159], a[68:71], v[96:99], v[144:159]
    s_waitcnt vmcnt(10) lgkmcnt(10)
    v_mfma_f32_32x32x16_bf16 v[128:143], a[72:75], v[100:103], v[128:143]
    buffer_load_dwordx4 v[60:63], v33, s[76:79], s25 offen offset:3072 sc1
    s_add_u32 s25, s25, 4096
    s_waitcnt lgkmcnt(8)
    v_mfma_f32_32x32x16_bf16 v[144:159], a[76:79], v[100:103], v[144:159]
    s_waitcnt vmcnt(10) lgkmcnt(6)
    v_mfma_f32_32x32x16_bf16 v[128:143], a[80:83], v[104:107], v[128:143]
    buffer_load_dwordx4 v[192:195], v33, s[76:79], s25 offen offset:0 sc1
    s_waitcnt lgkmcnt(4)
    v_mfma_f32_32x32x16_bf16 v[144:159], a[84:87], v[104:107], v[144:159]
    s_waitcnt vmcnt(10) lgkmcnt(2)
    v_mfma_f32_32x32x16_bf16 v[128:143], a[88:91], v[108:111], v[128:143]
    buffer_load_dwordx4 v[196:199], v33, s[76:79], s25 offen offset:1024 sc1
    s_waitcnt lgkmcnt(0)
    v_mfma_f32_32x32x16_bf16 v[144:159], a[92:95], v[108:111], v[144:159]
    s_waitcnt vmcnt(10)
    v_mfma_f32_32x32x16_bf16 v[160:175], a[96:99], v[112:115], 0
    buffer_load_dwordx4 v[200:203], v33, s[76:79], s25 offen offset:2048 sc1
    v_mfma_f32_32x32x16_bf16 v[176:191], a[100:103], v[112:115], 0
    s_waitcnt vmcnt(10)
    v_mfma_f32_32x32x16_bf16 v[160:175], a[104:107], v[116:119], v[160:175]
    buffer_load_dwordx4 v[204:207], v33, s[76:79], s25 offen offset:3072 sc1
    s_add_u32 s25, s25, 4096
    s_waitcnt vmcnt(9)
    v_cmp_ne_u32 vcc, s12, v34
    s_nop 1
    s_cbranch_vccnz L_slow7
L_back7:
    buffer_load_dwordx4 v[40:43], v7, s[76:79], s31 offen sc1
    v_mfma_f32_32x32x16_bf16 v[176:191], a[108:111], v[116:119], v[176:191]
    s_add_u32 s31, s31, 32768
    buffer_load_dwordx4 v[44:47], v7, s[76:79], s31 offen sc1
    ds_write_b128 v8, v[128:131] offset:0
    v_mfma_f32_32x32x16_bf16 v[160:175], a[112:115], v[120:123], v[160:175]
    buffer_load_dwordx4 v[208:211], v33, s[76:79], s25 offen offset:0 sc1
    v_mfma_f32_32x32x16_bf16 v[176:191], a[116:119], v[120:123], v[176:191]
    ds_write_b128 v8, v[132:135] offset:32
    s_waitcnt vmcnt(11)
    v_mfma_f32_32x32x16_bf16 v[160:175], a[120:123], v[124:127], v[160:175]
    buffer_load_dwordx4 v[212:215], v33, s[76:79], s25 offen offset:1024 sc1
    v_mfma_f32_32x32x16_bf16 v[176:191], a[124:127], v[124:127], v[176:191]
    ds_write_b128 v8, v[136:139] offset:64
    s_waitcnt vmcnt(11)
    v_mfma_f32_32x32x16_bf16 v[160:175], a[128:131], v[48:51], v[160:175]
    buffer_load_dwordx4 v[216:219], v33, s[76:79], s25 offen offset:2048 sc1
    v_mfma_f32_32x32x16_bf16 v[176:191], a[132:135], v[48:51], v[176:191]
    ds_write_b128 v8, v[140:143] offset:96
    s_waitcnt vmcnt(11)
    v_mfma_f32_32x32x16_bf16 v[160:175], a[136:139], v[52:55], v[160:175]
    buffer_load_dwordx4 v[220:223], v33, s[76:79], s25 offen offset:3072 sc1
    s_add_u32 s25, s25, 4096
    v_mfma_f32_32x32x16_bf16 v[176:191], a[140:143], v[52:55], v[176:191]
    ds_write_b128 v8, v[144:147] offset:128
    s_waitcnt vmcnt(11)
    v_mfma_f32_32x32x16_bf16 v[160:175], a[144:147], v[56:59], v[160:175]
    buffer_load_dwordx4 v[224:227], v33, s[76:79], s25 offen offset:0 sc1
    v_mfma_f32_32x32x16_bf16 v[176:191], a[148:151], v[56:59], v[176:191]
    ds_write_b128 v8, v[148:151] offset:160
    s_waitcnt vmcnt(11)
    v_mfma_f32_32x32x16_bf16 v[160:175], a[152:155], v[60:63], v[160:175]
    buffer_load_dwordx4 v[228:231], v33, s[76:79], s25 offen offset:1024 sc1
    v_mfma_f32_32x32x16_bf16 v[176:191], a[156:159], v[60:63], v[176:191]
    ds_write_b128 v8, v[152:155] offset:192
    s_waitcnt vmcnt(11)
    v_mfma_f32_32x32x16_bf16 v[160:175], a[160:163], v[192:195], v[160:175]
    buffer_load_dwordx4 v[232:235], v33, s[76:79], s25 offen offset:2048 sc1
    v_mfma_f32_32x32x16_bf16 v[176:191], a[164:167], v[192:195], v[176:191]
    ds_write_b128 v8, v[156:159] offset:224
    s_waitcnt vmcnt(11)
    v_mfma_f32_32x32x16_bf16 v[160:175], a[168:171], v[196:199], v[160:175]
    buffer_load_dwordx4 v[236:239], v33, s[76:79], s25 offen offset:3072 sc1
    s_add_u32 s25, s25, 4096
    v_mfma_f32_32x32x16_bf16 v[176:191], a[172:175], v[196:199], v[176:191]
    s_waitcnt vmcnt(11)
    v_mfma_f32_32x32x16_bf16 v[160:175], a[176:179], v[200:203], v[160:175]
    buffer_load_dwordx4 v[240:243], v33, s[76:79], s25 offen offset:0 sc1
    v_mfma_f32_32x32x16_bf16 v[176:191], a[180:183], v[200:203], v[176:191]
    s_waitcnt vmcnt(11)
    v_mfma_f32_32x32x16_bf16 v[160:175], a[184:187], v[204:207], v[160:175]
    buffer_load_dwordx4 v[244:247], v33, s[76:79], s25 offen offset:1024 sc1
    s_waitcnt vmcnt(11)
    ds_write_b128 v1, v[40:43]
    s_waitcnt vmcnt(10)
    ds_write_b128 v1, v[44:47] offset:1152
    v_mfma_f32_32x32x16_bf16 v[176:191], a[188:191], v[204:207], v[176:191]
    ds_read_b64_tr_b16 v[40:41], v2 offset:0
    ds_read_b64_tr_b16 v[42:43], v2 offset:576
    ds_read_b64_tr_b16 v[44:45], v2 offset:1152
    ds_read_b64_tr_b16 v[46:47], v2 offset:1728
    s_waitcnt vmcnt(9)
    v_mfma_f32_32x32x16_bf16 v[160:175], a[192:195], v[208:211], v[160:175]
    buffer_load_dwordx4 v[248:251], v33, s[76:79], s25 offen offset:2048 sc1
    v_lshlrev_b32 v128, 16, v16
    v_and_b32 v129, s15, v16
    v_lshlrev_b32 v130, 16, v17
    v_and_b32 v131, s15, v17
    v_mfma_f32_32x32x16_bf16 v[176:191], a[196:199], v[208:211], v[176:191]
    v_lshlrev_b32 v132, 16, v18
    v_and_b32 v133, s15, v18
    v_lshlrev_b32 v134, 16, v19
    v_and_b32 v135, s15, v19
    v_fma_f32 v136, v128, v24, v25
    s_waitcnt vmcnt(9)
    v_mfma_f32_32x32x16_bf16 v[160:175], a[200:203], v[212:215], v[160:175]
    buffer_load_dwordx4 v[252:255], v33, s[76:79], s25 offen offset:3072 sc1
    s_add_u32 s25, s25, 4096
    v_fma_f32 v137, v129, v24, v25
    v_fma_f32 v138, v130, v24, v25
    v_fma_f32 v139, v131, v24, v25
    v_mfma_f32_32x32x16_bf16 v[176:191], a[204:207], v[212:215], v[176:191]
    v_fma_f32 v140, v132, v24, v25
    v_fma_f32 v141, v133, v24, v25
    v_fma_f32 v142, v134, v24, v25
    v_fma_f32 v143, v135, v24, v25
    v_mov_b32 v26, v27
    s_waitcnt vmcnt(9)
    v_mfma_f32_32x32x16_bf16 v[160:175], a[208:211], v[216:219], v[160:175]
    buffer_load_dwordx4 v[64:67], v33, s[76:79], s25 offen offset:0 sc1
    s_waitcnt lgkmcnt(2)
    ds_write_b128 v3, v[40:43]
    s_waitcnt lgkmcnt(1)
    ds_write_b128 v3, v[44:47] offset:16
    v_lshlrev_b32 v144, 16, v20
    v_and_b32 v145, s15, v20
    v_mfma_f32_32x32x16_bf16 v[176:191], a[212:215], v[216:219], v[176:191]
    v_lshlrev_b32 v146, 16, v21
    v_and_b32 v147, s15, v21
    v_lshlrev_b32 v148, 16, v22
    v_and_b32 v149, s15, v22
    v_lshlrev_b32 v150, 16, v23
    s_waitcnt vmcnt(9)
    v_mfma_f32_32x32x16_bf16 v[160:175], a[216:219], v[220:223], v[160:175]
    buffer_load_dwordx4 v[68:71], v33, s[76:79], s25 offen offset:1024 sc1
    v_and_b32 v151, s15, v23
    v_fma_f32 v152, v144, v36, v37
    v_fma_f32 v153, v145, v36, v37
    v_fma_f32 v154, v146, v36, v37
    v_mfma_f32_32x32x16_bf16 v[176:191], a[220:223], v[220:223], v[176:191]
    v_fma_f32 v155, v147, v36, v37
    v_fma_f32 v156, v148, v36, v37
    v_fma_f32 v157, v149, v36, v37
    v_fma_f32 v158, v150, v36, v37
    v_fma_f32 v159, v151, v36, v37
    v_mov_b32 v38, v39
    s_waitcnt vmcnt(9)
    v_mfma_f32_32x32x16_bf16 v[160:175], a[0:3], v[224:227], v[160:175]
    s_waitcnt lgkmcnt(0)
    s_barrier
    ds_read_b128 v[112:115], v11 offset:0
    ds_read_b128 v[116:119], v11 offset:4608
    buffer_load_dwordx4 v[72:75], v33, s[76:79], s25 offen offset:2048 sc1
    v_mfma_f32_32x32x16_bf16 v[176:191], a[4:7], v[224:227], v[176:191]
    ds_read_b128 v[80:83], v9 offset:0
    ds_read_b128 v[84:87], v9 offset:16
    ds_read_b128 v[88:91], v9 offset:24704
    ds_read_b128 v[92:95], v9 offset:24720
    ds_read_b128 v[96:99], v10 offset:0
    s_waitcnt vmcnt(9)
    v_mfma_f32_32x32x16_bf16 v[160:175], a[8:11], v[228:231], v[160:175]
    buffer_load_dwordx4 v[76:79], v33, s[76:79], s25 offen offset:3072 sc1
    s_add_u32 s25, s25, 4096
    ds_read_b128 v[100:103], v10 offset:16
    ds_read_b128 v[104:107], v10 offset:24704
    ds_read_b128 v[108:111], v10 offset:24720
    v_mfma_f32_32x32x16_bf16 v[176:191], a[12:15], v[228:231], v[176:191]
    s_waitcnt vmcnt(9)
    v_mfma_f32_32x32x16_bf16 v[160:175], a[16:19], v[232:235], v[160:175]
    s_waitcnt lgkmcnt(9)
    v_lshlrev_b32 v120, 16, v112
    v_and_b32 v121, s15, v112
    v_lshlrev_b32 v122, 16, v113
    v_and_b32 v123, s15, v113
    v_lshlrev_b32 v124, 16, v114
    v_mfma_f32_32x32x16_bf16 v[176:191], a[20:23], v[232:235], v[176:191]
    v_and_b32 v125, s15, v114
    v_lshlrev_b32 v126, 16, v115
    v_and_b32 v127, s15, v115
    v_fmac_f32 v128, v136, v120
    v_fmac_f32 v129, v137, v121
    s_waitcnt vmcnt(8)
    v_mfma_f32_32x32x16_bf16 v[160:175], a[24:27], v[236:239], v[160:175]
    v_fmac_f32 v130, v138, v122
    v_fmac_f32 v131, v139, v123
    v_fmac_f32 v132, v140, v124
    v_fmac_f32 v133, v141, v125
    v_fmac_f32 v134, v142, v126
    v_mfma_f32_32x32x16_bf16 v[176:191], a[28:31], v[236:239], v[176:191]
    v_fmac_f32 v135, v143, v127
    s_waitcnt lgkmcnt(8)
    v_lshlrev_b32 v120, 16, v116
    v_and_b32 v121, s15, v116
    v_lshlrev_b32 v122, 16, v117
    v_and_b32 v123, s15, v117
    s_waitcnt vmcnt(7)
    v_mfma_f32_32x32x16_bf16 v[160:175], a[32:35], v[240:243], v[160:175]
    v_lshlrev_b32 v124, 16, v118
    v_and_b32 v125, s15, v118
    v_lshlrev_b32 v126, 16, v119
    v_and_b32 v127, s15, v119
    v_fmac_f32 v144, v152, v120
    v_mfma_f32_32x32x16_bf16 v[176:191], a[36:39], v[240:243], v[176:191]
    v_fmac_f32 v145, v153, v121
    v_fmac_f32 v146, v154, v122
    v_fmac_f32 v147, v155, v123
    v_fmac_f32 v148, v156, v124
    v_fmac_f32 v149, v157, v125
    s_waitcnt vmcnt(6)
    v_mfma_f32_32x32x16_bf16 v[160:175], a[40:43], v[244:247], v[160:175]
    v_fmac_f32 v150, v158, v126
    v_fmac_f32 v151, v159, v127
    s_waitcnt lgkmcnt(5)
    v_add_f32 v80, v80, v88
    v_add_f32 v81, v81, v89
    v_add_f32 v82, v82, v90
    v_mfma_f32_32x32x16_bf16 v[176:191], a[44:47], v[244:247], v[176:191]
    v_add_f32 v83, v83, v91
    s_waitcnt lgkmcnt(4)
    v_add_f32 v84, v84, v92
    v_add_f32 v85, v85, v93
    v_add_f32 v86, v86, v94
    v_add_f32 v87, v87, v95
    s_waitcnt vmcnt(5)
    v_mfma_f32_32x32x16_bf16 v[160:175], a[48:51], v[248:251], v[160:175]
    s_waitcnt lgkmcnt(1)
    v_add_f32 v96, v96, v104
    v_add_f32 v97, v97, v105
    v_add_f32 v98, v98, v106
    v_add_f32 v99, v99, v107
    s_waitcnt lgkmcnt(0)
    v_add_f32 v100, v100, v108
    s_waitcnt vmcnt(4)
    v_mfma_f32_32x32x16_bf16 v[160:175], a[56:59], v[252:255], v[160:175]
    v_add_f32 v101, v101, v109
    v_add_f32 v102, v102, v110
    v_add_f32 v103, v103, v111
    v_add_f32 v80, v80, v96
    v_add_f32 v81, v81, v97
    s_waitcnt vmcnt(3)
    v_mfma_f32_32x32x16_bf16 v[160:175], a[64:67], v[64:67], v[160:175]
    v_add_f32 v82, v82, v98
    v_add_f32 v83, v83, v99
    v_add_f32 v84, v84, v100
    v_add_f32 v85, v85, v101
    v_add_f32 v86, v86, v102
    s_waitcnt vmcnt(2)
    v_mfma_f32_32x32x16_bf16 v[160:175], a[72:75], v[68:71], v[160:175]
    v_add_f32 v87, v87, v103
    v_fma_f32 v80, v80, v27, v128
    v_fma_f32 v81, v81, v27, v129
    v_fma_f32 v82, v82, v27, v130
    v_fma_f32 v83, v83, v27, v131
    s_waitcnt vmcnt(1)
    v_mfma_f32_32x32x16_bf16 v[160:175], a[80:83], v[72:75], v[160:175]
    v_fma_f32 v84, v84, v27, v132
    v_fma_f32 v85, v85, v27, v133
    v_fma_f32 v86, v86, v27, v134
    v_fma_f32 v87, v87, v27, v135
    v_cvt_pk_bf16_f32 v88, v80, v81
    s_waitcnt vmcnt(0)
    v_mfma_f32_32x32x16_bf16 v[160:175], a[88:91], v[76:79], v[160:175]
    v_cvt_pk_bf16_f32 v89, v82, v83
    v_cvt_pk_bf16_f32 v90, v84, v85
    v_cvt_pk_bf16_f32 v91, v86, v87
    buffer_store_dwordx4 v[88:91], v29, s[72:75], s29 offen
    v_mfma_f32_32x32x16_bf16 v[176:191], a[52:55], v[248:251], v[176:191]
    v_mfma_f32_32x32x16_bf16 v[176:191], a[60:63], v[252:255], v[176:191]
    v_mfma_f32_32x32x16_bf16 v[176:191], a[68:71], v[64:67], v[176:191]
    s_nop 4
    ds_write_b128 v8, v[160:163] offset:8704
    v_mfma_f32_32x32x16_bf16 v[176:191], a[76:79], v[68:71], v[176:191]
    ds_write_b128 v8, v[164:167] offset:8736
    v_mfma_f32_32x32x16_bf16 v[176:191], a[84:87], v[72:75], v[176:191]
    ds_write_b128 v8, v[168:171] offset:8768
    v_mfma_f32_32x32x16_bf16 v[176:191], a[92:95], v[76:79], v[176:191]
    ds_write_b128 v8, v[172:175] offset:8800
    s_nop 10
    ds_write_b128 v8, v[176:179] offset:8832
    ds_write_b128 v8, v[180:183] offset:8864
    ds_write_b128 v8, v[184:187] offset:8896
    ds_write_b128 v8, v[188:191] offset:8928
    s_waitcnt lgkmcnt(0)
    s_barrier
    ds_read_b128 v[192:195], v9 offset:8704
    ds_read_b128 v[196:199], v9 offset:8720
    ds_read_b128 v[200:203], v9 offset:33408
    ds_read_b128 v[204:207], v9 offset:33424
    ds_read_b128 v[208:211], v10 offset:8704
    ds_read_b128 v[212:215], v10 offset:8720
    ds_read_b128 v[216:219], v10 offset:33408
    ds_read_b128 v[220:223], v10 offset:33424
    s_waitcnt lgkmcnt(5)
    v_pk_add_f32 v[192:193], v[192:193], v[200:201]
    v_pk_add_f32 v[194:195], v[194:195], v[202:203]
    s_waitcnt lgkmcnt(4)
    v_pk_add_f32 v[196:197], v[196:197], v[204:205]
    v_pk_add_f32 v[198:199], v[198:199], v[206:207]
    s_waitcnt lgkmcnt(1)
    v_pk_add_f32 v[208:209], v[208:209], v[216:217]
    v_pk_add_f32 v[210:211], v[210:211], v[218:219]
    s_waitcnt lgkmcnt(0)
    v_pk_add_f32 v[212:213], v[212:213], v[220:221]
    v_pk_add_f32 v[214:215], v[214:215], v[222:223]
    v_pk_add_f32 v[192:193], v[192:193], v[208:209]
    v_pk_add_f32 v[194:195], v[194:195], v[210:211]
    v_pk_add_f32 v[196:197], v[196:197], v[212:213]
    v_pk_add_f32 v[198:199], v[198:199], v[214:215]
    v_pk_fma_f32 v[192:193], v[192:193], v[38:39], v[144:145]
    v_pk_fma_f32 v[194:195], v[194:195], v[38:39], v[146:147]
    v_pk_fma_f32 v[196:197], v[196:197], v[38:39], v[148:149]
    v_pk_fma_f32 v[198:199], v[198:199], v[38:39], v[150:151]
    v_cvt_pk_bf16_f32 v200, v192, v193
    v_cvt_pk_bf16_f32 v201, v194, v195
    v_cvt_pk_bf16_f32 v202, v196, v197
    v_cvt_pk_bf16_f32 v203, v198, v199
    buffer_store_dwordx4 v[200:203], v29, s[72:75], s11 offen
L_end:
    s_endpgm
L_apath:
    s_lshr_b32 s18, s4, 1
    s_min_u32 s18, s18, 6
    s_add_u32 s18, s18, s5
    s_sub_u32 s18, s18, 7
    s_mov_b32 s24, 12859392
    v_lshrrev_b32 v2, 4, v0
    v_mul_u32_u24 v2, 3584, v2
    v_and_b32 v3, 15, v0
    v_lshl_add_u32 v2, v3, 4, v2
    s_mul_i32 s9, s3, 458752
    s_lshl_b32 s10, s18, 8
    s_add_u32 s9, s9, s10
    s_mov_b32 s10, 0x3f803f80
    buffer_load_dwordx4 v[128:131], v2, s[64:67], s9 offen
    s_add_u32 s9, s9, 14336
    s_waitcnt vmcnt(23)
    v_dot2_f32_bf16 v4, v64, s10, 0
    v_dot2_f32_bf16 v6, v64, v64, 0
    v_dot2_f32_bf16 v5, v65, s10, 0
    v_dot2_f32_bf16 v7, v65, v65, 0
    v_dot2_f32_bf16 v4, v66, s10, v4
    v_dot2_f32_bf16 v6, v66, v66, v6
    v_dot2_f32_bf16 v5, v67, s10, v5
    v_dot2_f32_bf16 v7, v67, v67, v7
    s_waitcnt vmcnt(22)
    v_dot2_f32_bf16 v4, v68, s10, v4
    v_dot2_f32_bf16 v6, v68, v68, v6
    v_dot2_f32_bf16 v5, v69, s10, v5
    v_dot2_f32_bf16 v7, v69, v69, v7
    v_dot2_f32_bf16 v4, v70, s10, v4
    v_dot2_f32_bf16 v6, v70, v70, v6
    v_dot2_f32_bf16 v5, v71, s10, v5
    v_dot2_f32_bf16 v7, v71, v71, v7
    buffer_load_dwordx4 v[132:135], v2, s[64:67], s9 offen
    s_add_u32 s9, s9, 14336
    s_waitcnt vmcnt(22)
    v_dot2_f32_bf16 v4, v72, s10, v4
    v_dot2_f32_bf16 v6, v72, v72, v6
    v_dot2_f32_bf16 v5, v73, s10, v5
    v_dot2_f32_bf16 v7, v73, v73, v7
    v_dot2_f32_bf16 v4, v74, s10, v4
    v_dot2_f32_bf16 v6, v74, v74, v6
    v_dot2_f32_bf16 v5, v75, s10, v5
    v_dot2_f32_bf16 v7, v75, v75, v7
    s_waitcnt vmcnt(21)
    v_dot2_f32_bf16 v4, v76, s10, v4
    v_dot2_f32_bf16 v6, v76, v76, v6
    v_dot2_f32_bf16 v5, v77, s10, v5
    v_dot2_f32_bf16 v7, v77, v77, v7
    v_dot2_f32_bf16 v4, v78, s10, v4
    v_dot2_f32_bf16 v6, v78, v78, v6
    v_dot2_f32_bf16 v5, v79, s10, v5
    v_dot2_f32_bf16 v7, v79, v79, v7
    buffer_load_dwordx4 v[136:139], v2, s[64:67], s9 offen
    s_add_u32 s9, s9, 14336
    s_waitcnt vmcnt(21)
    v_dot2_f32_bf16 v4, v80, s10, v4
    v_dot2_f32_bf16 v6, v80, v80, v6
    v_dot2_f32_bf16 v5, v81, s10, v5
    v_dot2_f32_bf16 v7, v81, v81, v7
    v_dot2_f32_bf16 v4, v82, s10, v4
    v_dot2_f32_bf16 v6, v82, v82, v6
    v_dot2_f32_bf16 v5, v83, s10, v5
    v_dot2_f32_bf16 v7, v83, v83, v7
    s_waitcnt vmcnt(20)
    v_dot2_f32_bf16 v4, v84, s10, v4
    v_dot2_f32_bf16 v6, v84, v84, v6
    v_dot2_f32_bf16 v5, v85, s10, v5
    v_dot2_f32_bf16 v7, v85, v85, v7
    v_dot2_f32_bf16 v4, v86, s10, v4
    v_dot2_f32_bf16 v6, v86, v86, v6
    v_dot2_f32_bf16 v5, v87, s10, v5
    v_dot2_f32_bf16 v7, v87, v87, v7
    buffer_load_dwordx4 v[140:143], v2, s[64:67], s9 offen
    s_add_u32 s9, s9, 14336
    s_waitcnt vmcnt(20)
    v_dot2_f32_bf16 v4, v88, s10, v4
    v_dot2_f32_bf16 v6, v88, v88, v6
    v_dot2_f32_bf16 v5, v89, s10, v5
    v_dot2_f32_bf16 v7, v89, v89, v7
    v_dot2_f32_bf16 v4, v90, s10, v4
    v_dot2_f32_bf16 v6, v90, v90, v6
    v_dot2_f32_bf16 v5, v91, s10, v5
    v_dot2_f32_bf16 v7, v91, v91, v7
    s_waitcnt vmcnt(19)
    v_dot2_f32_bf16 v4, v92, s10, v4
    v_dot2_f32_bf16 v6, v92, v92, v6
    v_dot2_f32_bf16 v5, v93, s10, v5
    v_dot2_f32_bf16 v7, v93, v93, v7
    v_dot2_f32_bf16 v4, v94, s10, v4
    v_dot2_f32_bf16 v6, v94, v94, v6
    v_dot2_f32_bf16 v5, v95, s10, v5
    v_dot2_f32_bf16 v7, v95, v95, v7
    buffer_load_dwordx4 v[144:147], v2, s[64:67], s9 offen
    s_add_u32 s9, s9, 14336
    s_waitcnt vmcnt(19)
    v_dot2_f32_bf16 v8, v96, s10, 0
    v_dot2_f32_bf16 v10, v96, v96, 0
    v_dot2_f32_bf16 v9, v97, s10, 0
    v_dot2_f32_bf16 v11, v97, v97, 0
    v_dot2_f32_bf16 v8, v98, s10, v8
    v_dot2_f32_bf16 v10, v98, v98, v10
    v_dot2_f32_bf16 v9, v99, s10, v9
    v_dot2_f32_bf16 v11, v99, v99, v11
    s_waitcnt vmcnt(18)
    v_dot2_f32_bf16 v8, v100, s10, v8
    v_dot2_f32_bf16 v10, v100, v100, v10
    v_dot2_f32_bf16 v9, v101, s10, v9
    v_dot2_f32_bf16 v11, v101, v101, v11
    v_dot2_f32_bf16 v8, v102, s10, v8
    v_dot2_f32_bf16 v10, v102, v102, v10
    v_dot2_f32_bf16 v9, v103, s10, v9
    v_dot2_f32_bf16 v11, v103, v103, v11
    buffer_load_dwordx4 v[148:151], v2, s[64:67], s9 offen
    s_add_u32 s9, s9, 14336
    s_waitcnt vmcnt(18)
    v_dot2_f32_bf16 v8, v104, s10, v8
    v_dot2_f32_bf16 v10, v104, v104, v10
    v_dot2_f32_bf16 v9, v105, s10, v9
    v_dot2_f32_bf16 v11, v105, v105, v11
    v_dot2_f32_bf16 v8, v106, s10, v8
    v_dot2_f32_bf16 v10, v106, v106, v10
    v_dot2_f32_bf16 v9, v107, s10, v9
    v_dot2_f32_bf16 v11, v107, v107, v11
    s_waitcnt vmcnt(17)
    v_dot2_f32_bf16 v8, v108, s10, v8
    v_dot2_f32_bf16 v10, v108, v108, v10
    v_dot2_f32_bf16 v9, v109, s10, v9
    v_dot2_f32_bf16 v11, v109, v109, v11
    v_dot2_f32_bf16 v8, v110, s10, v8
    v_dot2_f32_bf16 v10, v110, v110, v10
    v_dot2_f32_bf16 v9, v111, s10, v9
    v_dot2_f32_bf16 v11, v111, v111, v11
    buffer_load_dwordx4 v[152:155], v2, s[64:67], s9 offen
    s_add_u32 s9, s9, 14336
    s_waitcnt vmcnt(17)
    v_dot2_f32_bf16 v8, v112, s10, v8
    v_dot2_f32_bf16 v10, v112, v112, v10
    v_dot2_f32_bf16 v9, v113, s10, v9
    v_dot2_f32_bf16 v11, v113, v113, v11
    v_dot2_f32_bf16 v8, v114, s10, v8
    v_dot2_f32_bf16 v10, v114, v114, v10
    v_dot2_f32_bf16 v9, v115, s10, v9
    v_dot2_f32_bf16 v11, v115, v115, v11
    s_waitcnt vmcnt(16)
    v_dot2_f32_bf16 v8, v116, s10, v8
    v_dot2_f32_bf16 v10, v116, v116, v10
    v_dot2_f32_bf16 v9, v117, s10, v9
    v_dot2_f32_bf16 v11, v117, v117, v11
    v_dot2_f32_bf16 v8, v118, s10, v8
    v_dot2_f32_bf16 v10, v118, v118, v10
    v_dot2_f32_bf16 v9, v119, s10, v9
    v_dot2_f32_bf16 v11, v119, v119, v11
    buffer_load_dwordx4 v[156:159], v2, s[64:67], s9 offen
    s_add_u32 s9, s9, 14336
    s_waitcnt vmcnt(16)
    v_dot2_f32_bf16 v8, v120, s10, v8
    v_dot2_f32_bf16 v10, v120, v120, v10
    v_dot2_f32_bf16 v9, v121, s10, v9
    v_dot2_f32_bf16 v11, v121, v121, v11
    v_dot2_f32_bf16 v8, v122, s10, v8
    v_dot2_f32_bf16 v10, v122, v122, v10
    v_dot2_f32_bf16 v9, v123, s10, v9
    v_dot2_f32_bf16 v11, v123, v123, v11
    s_waitcnt vmcnt(15)
    v_dot2_f32_bf16 v8, v124, s10, v8
    v_dot2_f32_bf16 v10, v124, v124, v10
    v_dot2_f32_bf16 v9, v125, s10, v9
    v_dot2_f32_bf16 v11, v125, v125, v11
    v_dot2_f32_bf16 v8, v126, s10, v8
    v_dot2_f32_bf16 v10, v126, v126, v10
    v_dot2_f32_bf16 v9, v127, s10, v9
    v_dot2_f32_bf16 v11, v127, v127, v11
    s_waitcnt vmcnt(9)
    s_barrier
    ds_read2_b32 v[64:65], v26 offset0:0 offset1:32
    ds_read_b32 v66, v26 offset:256
    ds_read2_b32 v[68:69], v24 offset0:0 offset1:32
    ds_read2_b32 v[70:71], v24 offset0:64 offset1:96
    ds_read2_b32 v[72:73], v24 offset0:128 offset1:160
    ds_read2_b32 v[74:75], v24 offset0:192 offset1:224
    ds_read2_b32 v[80:81], v25 offset0:0 offset1:32
    ds_read2_b32 v[82:83], v25 offset0:64 offset1:96
    ds_read2_b32 v[84:85], v25 offset0:128 offset1:160
    ds_read2_b32 v[86:87], v25 offset0:192 offset1:224
    v_add_f32 v4, v4, v5
    v_add_f32 v6, v6, v7
    v_add_f32 v8, v8, v9
    v_add_f32 v10, v10, v11
    v_add_f32_dpp v4, v4, v4 quad_perm:[1,0,3,2] row_mask:0xf bank_mask:0xf
    v_add_f32_dpp v6, v6, v6 quad_perm:[1,0,3,2] row_mask:0xf bank_mask:0xf
    v_add_f32_dpp v8, v8, v8 quad_perm:[1,0,3,2] row_mask:0xf bank_mask:0xf
    v_add_f32_dpp v10, v10, v10 quad_perm:[1,0,3,2] row_mask:0xf bank_mask:0xf
    v_add_f32_dpp v4, v4, v4 quad_perm:[2,3,0,1] row_mask:0xf bank_mask:0xf
    v_add_f32_dpp v6, v6, v6 quad_perm:[2,3,0,1] row_mask:0xf bank_mask:0xf
    v_add_f32_dpp v8, v8, v8 quad_perm:[2,3,0,1] row_mask:0xf bank_mask:0xf
    v_add_f32_dpp v10, v10, v10 quad_perm:[2,3,0,1] row_mask:0xf bank_mask:0xf
    v_add_f32_dpp v4, v4, v4 row_half_mirror row_mask:0xf bank_mask:0xf
    v_add_f32_dpp v6, v6, v6 row_half_mirror row_mask:0xf bank_mask:0xf
    v_add_f32_dpp v8, v8, v8 row_half_mirror row_mask:0xf bank_mask:0xf
    v_add_f32_dpp v10, v10, v10 row_half_mirror row_mask:0xf bank_mask:0xf
    v_mul_f32 v4, 0xbb000000, v4
    v_mul_f32 v6, 0x3b000000, v6
    v_fma_f32 v6, -v4, v4, v6
    v_max_f32 v6, 0, v6
    v_cvt_pk_bf16_f32 v6, v6, v6
    v_lshlrev_b32 v6, 16, v6
    v_cvt_pk_bf16_f32 v14, v4, v4
    v_lshlrev_b32 v4, 16, v14
    v_add_f32 v6, 0x3727c5ac, v6
    v_cvt_pk_bf16_f32 v6, v6, v6
    v_lshlrev_b32 v6, 16, v6
    v_sqrt_f32 v6, v6
    s_nop 0
    v_cvt_pk_bf16_f32 v6, v6, v6
    v_lshlrev_b32 v6, 16, v6
    v_rcp_f32 v12, v6
    s_nop 0
    v_mul_f32 v13, v4, v12
    v_mul_f32 v15, v12, v12
    v_mul_f32 v8, 0xbb000000, v8
    v_mul_f32 v10, 0x3b000000, v10
    v_fma_f32 v10, -v8, v8, v10
    v_max_f32 v10, 0, v10
    v_cvt_pk_bf16_f32 v10, v10, v10
    v_lshlrev_b32 v10, 16, v10
    v_cvt_pk_bf16_f32 v18, v8, v8
    v_lshlrev_b32 v8, 16, v18
    v_add_f32 v10, 0x3727c5ac, v10
    v_cvt_pk_bf16_f32 v10, v10, v10
    v_lshlrev_b32 v10, 16, v10
    v_sqrt_f32 v10, v10
    s_nop 0
    v_cvt_pk_bf16_f32 v10, v10, v10
    v_lshlrev_b32 v10, 16, v10
    v_rcp_f32 v16, v10
    s_nop 0
    v_mul_f32 v17, v8, v16
    v_mul_f32 v19, v16, v16
    v_and_b32 v3, 7, v0
    v_lshlrev_b32 v3, 24, v3
    v_lshl_add_u32 v3, v0, 1, v3
    s_lshl_b32 s10, s17, 8
    s_add_u32 s10, s10, 12582912
    buffer_store_dwordx4 v[12:15], v3, s[76:79], s10 offen sc1
    buffer_store_dwordx4 v[16:19], v3, s[76:79], s10 offen offset:128 sc1
    buffer_load_dwordx4 v[160:163], v2, s[64:67], s9 offen
    s_add_u32 s9, s9, 14336
    v_lshlrev_b32 v110, 16, v44
    v_and_b32 v112, s15, v44
    v_lshlrev_b32 v114, 16, v45
    v_and_b32 v116, s15, v45
    v_lshlrev_b32 v111, 16, v46
    v_and_b32 v113, s15, v46
    v_lshlrev_b32 v115, 16, v47
    v_and_b32 v117, s15, v47
    buffer_load_dwordx4 v[164:167], v2, s[64:67], s9 offen
    s_add_u32 s9, s9, 14336
    s_waitcnt lgkmcnt(9)
    v_lshlrev_b32 v88, 16, v64
    v_and_b32 v89, s15, v64
    v_lshlrev_b32 v90, 16, v65
    v_and_b32 v91, s15, v65
    s_waitcnt lgkmcnt(8)
    v_lshlrev_b32 v92, 16, v66
    v_and_b32 v93, s15, v66
    s_waitcnt lgkmcnt(7)
    v_lshlrev_b32 v94, 16, v68
    v_and_b32 v95, s15, v68
    buffer_load_dwordx4 v[168:171], v2, s[64:67], s9 offen
    s_add_u32 s9, s9, 14336
    v_lshlrev_b32 v96, 16, v69
    v_and_b32 v97, s15, v69
    s_waitcnt lgkmcnt(6)
    v_lshlrev_b32 v98, 16, v70
    v_and_b32 v99, s15, v70
    v_lshlrev_b32 v100, 16, v71
    v_and_b32 v101, s15, v71
    s_waitcnt lgkmcnt(5)
    v_lshlrev_b32 v102, 16, v72
    v_and_b32 v103, s15, v72
    buffer_load_dwordx4 v[172:175], v2, s[64:67], s9 offen
    s_add_u32 s9, s9, 14336
    v_lshlrev_b32 v104, 16, v73
    v_and_b32 v105, s15, v73
    s_waitcnt lgkmcnt(4)
    v_lshlrev_b32 v106, 16, v74
    v_and_b32 v107, s15, v74
    v_lshlrev_b32 v108, 16, v75
    v_and_b32 v109, s15, v75
    v_pk_mul_f32 v[64:65], v[94:95], v[110:111]
    v_pk_mul_f32 v[66:67], v[96:97], v[110:111]
    buffer_load_dwordx4 v[176:179], v2, s[64:67], s9 offen
    s_add_u32 s9, s9, 14336
    v_pk_mul_f32 v[68:69], v[98:99], v[110:111]
    v_pk_mul_f32 v[70:71], v[100:101], v[110:111]
    v_pk_mul_f32 v[72:73], v[102:103], v[110:111]
    v_pk_mul_f32 v[74:75], v[104:105], v[110:111]
    v_pk_mul_f32 v[76:77], v[106:107], v[110:111]
    v_pk_mul_f32 v[78:79], v[108:109], v[110:111]
    v_pk_fma_f32 v[64:65], v[92:93], v[112:113], v[64:65]
    v_pk_fma_f32 v[66:67], v[94:95], v[112:113], v[66:67]
    buffer_load_dwordx4 v[180:183], v2, s[64:67], s9 offen
    s_add_u32 s9, s9, 14336
    v_pk_fma_f32 v[68:69], v[96:97], v[112:113], v[68:69]
    v_pk_fma_f32 v[70:71], v[98:99], v[112:113], v[70:71]
    v_pk_fma_f32 v[72:73], v[100:101], v[112:113], v[72:73]
    v_pk_fma_f32 v[74:75], v[102:103], v[112:113], v[74:75]
    v_pk_fma_f32 v[76:77], v[104:105], v[112:113], v[76:77]
    v_pk_fma_f32 v[78:79], v[106:107], v[112:113], v[78:79]
    v_pk_fma_f32 v[64:65], v[90:91], v[114:115], v[64:65]
    v_pk_fma_f32 v[66:67], v[92:93], v[114:115], v[66:67]
    buffer_load_dwordx4 v[184:187], v2, s[64:67], s9 offen
    s_add_u32 s9, s9, 14336
    v_pk_fma_f32 v[68:69], v[94:95], v[114:115], v[68:69]
    v_pk_fma_f32 v[70:71], v[96:97], v[114:115], v[70:71]
    v_pk_fma_f32 v[72:73], v[98:99], v[114:115], v[72:73]
    v_pk_fma_f32 v[74:75], v[100:101], v[114:115], v[74:75]
    v_pk_fma_f32 v[76:77], v[102:103], v[114:115], v[76:77]
    v_pk_fma_f32 v[78:79], v[104:105], v[114:115], v[78:79]
    v_pk_fma_f32 v[64:65], v[88:89], v[116:117], v[64:65]
    v_pk_fma_f32 v[66:67], v[90:91], v[116:117], v[66:67]
    buffer_load_dwordx4 v[188:191], v2, s[64:67], s9 offen
    s_add_u32 s9, s9, 14336
    v_pk_fma_f32 v[68:69], v[92:93], v[116:117], v[68:69]
    v_pk_fma_f32 v[70:71], v[94:95], v[116:117], v[70:71]
    v_pk_fma_f32 v[72:73], v[96:97], v[116:117], v[72:73]
    v_pk_fma_f32 v[74:75], v[98:99], v[116:117], v[74:75]
    v_pk_fma_f32 v[76:77], v[100:101], v[116:117], v[76:77]
    v_pk_fma_f32 v[78:79], v[102:103], v[116:117], v[78:79]
    s_waitcnt lgkmcnt(3)
    v_lshlrev_b32 v88, 16, v80
    v_and_b32 v89, s15, v80
    buffer_load_dwordx4 v[192:195], v2, s[64:67], s9 offen
    s_add_u32 s9, s9, 14336
    v_lshlrev_b32 v90, 16, v81
    v_and_b32 v91, s15, v81
    s_waitcnt lgkmcnt(2)
    v_lshlrev_b32 v92, 16, v82
    v_and_b32 v93, s15, v82
    v_lshlrev_b32 v94, 16, v83
    v_and_b32 v95, s15, v83
    s_waitcnt lgkmcnt(1)
    v_lshlrev_b32 v96, 16, v84
    v_and_b32 v97, s15, v84
    buffer_load_dwordx4 v[196:199], v2, s[64:67], s9 offen
    s_add_u32 s9, s9, 14336
    v_lshlrev_b32 v98, 16, v85
    v_and_b32 v99, s15, v85
    s_waitcnt lgkmcnt(0)
    v_lshlrev_b32 v100, 16, v86
    v_and_b32 v101, s15, v86
    v_lshlrev_b32 v102, 16, v87
    v_and_b32 v103, s15, v87
    v_pk_mul_f32 v[64:65], v[64:65], v[88:89]
    v_pk_mul_f32 v[66:67], v[66:67], v[90:91]
    buffer_load_dwordx4 v[200:203], v2, s[64:67], s9 offen
    s_add_u32 s9, s9, 14336
    v_pk_mul_f32 v[68:69], v[68:69], v[92:93]
    v_pk_mul_f32 v[70:71], v[70:71], v[94:95]
    v_pk_mul_f32 v[72:73], v[72:73], v[96:97]
    v_pk_mul_f32 v[74:75], v[74:75], v[98:99]
    v_pk_mul_f32 v[76:77], v[76:77], v[100:101]
    v_pk_mul_f32 v[78:79], v[78:79], v[102:103]
    v_cvt_pk_bf16_f32 v40, v78, v76
    v_cvt_pk_bf16_f32 v41, v74, v72
    buffer_load_dwordx4 v[204:207], v2, s[64:67], s9 offen
    s_add_u32 s9, s9, 14336
    v_cvt_pk_bf16_f32 v42, v70, v68
    v_cvt_pk_bf16_f32 v43, v66, v64
    v_cvt_pk_bf16_f32 v44, v79, v77
    v_cvt_pk_bf16_f32 v45, v75, v73
    v_cvt_pk_bf16_f32 v46, v71, v69
    v_cvt_pk_bf16_f32 v47, v67, v65
    buffer_store_dwordx4 v[40:43], v30, s[76:79], s80 offen sc1
    s_add_u32 s80, s80, 4096
    buffer_store_dwordx4 v[44:47], v30, s[76:79], s80 offen sc1
    s_waitcnt vmcnt(14)
    s_lshl_b32 s17, s17, 7
    s_add_u32 s17, s17, 12713984
    s_mov_b64 exec, 0x1
    buffer_store_dword v31, v32, s[76:79], s17 offen sc1
    s_mov_b64 exec, -1
    s_mov_b32 s10, 0x3f80
    s_mov_b32 s11, 0x3f800000
    buffer_load_dwordx4 v[208:211], v2, s[64:67], s9 offen
    s_add_u32 s9, s9, 14336
    v_dot2_f32_bf16 v100, v128, s10, 0
    v_dot2_f32_bf16 v101, v128, s11, 0
    v_dot2_f32_bf16 v102, v129, s10, 0
    v_dot2_f32_bf16 v103, v129, s11, 0
    v_dot2_f32_bf16 v104, v130, s10, 0
    v_dot2_f32_bf16 v105, v130, s11, 0
    v_dot2_f32_bf16 v106, v131, s10, 0
    v_dot2_f32_bf16 v107, v131, s11, 0
    buffer_load_dwordx4 v[212:215], v2, s[64:67], s9 offen
    s_add_u32 s9, s9, 14336
    v_dot2_f32_bf16 v100, v132, s10, v100
    v_dot2_f32_bf16 v101, v132, s11, v101
    v_dot2_f32_bf16 v102, v133, s10, v102
    v_dot2_f32_bf16 v103, v133, s11, v103
    v_dot2_f32_bf16 v104, v134, s10, v104
    v_dot2_f32_bf16 v105, v134, s11, v105
    v_dot2_f32_bf16 v106, v135, s10, v106
    v_dot2_f32_bf16 v107, v135, s11, v107
    buffer_load_dwordx4 v[216:219], v2, s[64:67], s9 offen
    s_add_u32 s9, s9, 14336
    v_dot2_f32_bf16 v100, v136, s10, v100
    v_dot2_f32_bf16 v101, v136, s11, v101
    v_dot2_f32_bf16 v102, v137, s10, v102
    v_dot2_f32_bf16 v103, v137, s11, v103
    v_dot2_f32_bf16 v104, v138, s10, v104
    v_dot2_f32_bf16 v105, v138, s11, v105
    v_dot2_f32_bf16 v106, v139, s10, v106
    v_dot2_f32_bf16 v107, v139, s11, v107
    buffer_load_dwordx4 v[220:223], v2, s[64:67], s9 offen
    s_add_u32 s9, s9, 14336
    v_dot2_f32_bf16 v100, v140, s10, v100
    v_dot2_f32_bf16 v101, v140, s11, v101
    v_dot2_f32_bf16 v102, v141, s10, v102
    v_dot2_f32_bf16 v103, v141, s11, v103
    v_dot2_f32_bf16 v104, v142, s10, v104
    v_dot2_f32_bf16 v105, v142, s11, v105
    v_dot2_f32_bf16 v106, v143, s10, v106
    v_dot2_f32_bf16 v107, v143, s11, v107
    buffer_load_dwordx4 v[224:227], v2, s[64:67], s9 offen
    s_add_u32 s9, s9, 14336
    v_dot2_f32_bf16 v100, v144, s10, v100
    v_dot2_f32_bf16 v101, v144, s11, v101
    v_dot2_f32_bf16 v102, v145, s10, v102
    v_dot2_f32_bf16 v103, v145, s11, v103
    v_dot2_f32_bf16 v104, v146, s10, v104
    v_dot2_f32_bf16 v105, v146, s11, v105
    v_dot2_f32_bf16 v106, v147, s10, v106
    v_dot2_f32_bf16 v107, v147, s11, v107
    buffer_load_dwordx4 v[228:231], v2, s[64:67], s9 offen
    s_add_u32 s9, s9, 14336
    v_dot2_f32_bf16 v100, v148, s10, v100
    v_dot2_f32_bf16 v101, v148, s11, v101
    v_dot2_f32_bf16 v102, v149, s10, v102
    v_dot2_f32_bf16 v103, v149, s11, v103
    v_dot2_f32_bf16 v104, v150, s10, v104
    v_dot2_f32_bf16 v105, v150, s11, v105
    v_dot2_f32_bf16 v106, v151, s10, v106
    v_dot2_f32_bf16 v107, v151, s11, v107
    buffer_load_dwordx4 v[232:235], v2, s[64:67], s9 offen
    s_add_u32 s9, s9, 14336
    v_dot2_f32_bf16 v100, v152, s10, v100
    v_dot2_f32_bf16 v101, v152, s11, v101
    v_dot2_f32_bf16 v102, v153, s10, v102
    v_dot2_f32_bf16 v103, v153, s11, v103
    v_dot2_f32_bf16 v104, v154, s10, v104
    v_dot2_f32_bf16 v105, v154, s11, v105
    v_dot2_f32_bf16 v106, v155, s10, v106
    v_dot2_f32_bf16 v107, v155, s11, v107
    buffer_load_dwordx4 v[236:239], v2, s[64:67], s9 offen
    s_add_u32 s9, s9, 14336
    v_dot2_f32_bf16 v100, v156, s10, v100
    v_dot2_f32_bf16 v101, v156, s11, v101
    v_dot2_f32_bf16 v102, v157, s10, v102
    v_dot2_f32_bf16 v103, v157, s11, v103
    v_dot2_f32_bf16 v104, v158, s10, v104
    v_dot2_f32_bf16 v105, v158, s11, v105
    v_dot2_f32_bf16 v106, v159, s10, v106
    v_dot2_f32_bf16 v107, v159, s11, v107
    buffer_load_dwordx4 v[240:243], v2, s[64:67], s9 offen
    s_add_u32 s9, s9, 14336
    s_waitcnt vmcnt(23)
    v_dot2_f32_bf16 v100, v160, s10, v100
    v_dot2_f32_bf16 v101, v160, s11, v101
    v_dot2_f32_bf16 v102, v161, s10, v102
    v_dot2_f32_bf16 v103, v161, s11, v103
    v_dot2_f32_bf16 v104, v162, s10, v104
    v_dot2_f32_bf16 v105, v162, s11, v105
    v_dot2_f32_bf16 v106, v163, s10, v106
    v_dot2_f32_bf16 v107, v163, s11, v107
    buffer_load_dwordx4 v[244:247], v2, s[64:67], s9 offen
    s_add_u32 s9, s9, 14336
    s_waitcnt vmcnt(23)
    v_dot2_f32_bf16 v100, v164, s10, v100
    v_dot2_f32_bf16 v101, v164, s11, v101
    v_dot2_f32_bf16 v102, v165, s10, v102
    v_dot2_f32_bf16 v103, v165, s11, v103
    v_dot2_f32_bf16 v104, v166, s10, v104
    v_dot2_f32_bf16 v105, v166, s11, v105
    v_dot2_f32_bf16 v106, v167, s10, v106
    v_dot2_f32_bf16 v107, v167, s11, v107
    buffer_load_dwordx4 v[248:251], v2, s[64:67], s9 offen
    s_add_u32 s9, s9, 14336
    s_waitcnt vmcnt(23)
    v_dot2_f32_bf16 v100, v168, s10, v100
    v_dot2_f32_bf16 v101, v168, s11, v101
    v_dot2_f32_bf16 v102, v169, s10, v102
    v_dot2_f32_bf16 v103, v169, s11, v103
    v_dot2_f32_bf16 v104, v170, s10, v104
    v_dot2_f32_bf16 v105, v170, s11, v105
    v_dot2_f32_bf16 v106, v171, s10, v106
    v_dot2_f32_bf16 v107, v171, s11, v107
    buffer_load_dwordx4 v[252:255], v2, s[64:67], s9 offen
    s_add_u32 s9, s9, 14336
    s_waitcnt vmcnt(23)
    v_dot2_f32_bf16 v100, v172, s10, v100
    v_dot2_f32_bf16 v101, v172, s11, v101
    v_dot2_f32_bf16 v102, v173, s10, v102
    v_dot2_f32_bf16 v103, v173, s11, v103
    v_dot2_f32_bf16 v104, v174, s10, v104
    v_dot2_f32_bf16 v105, v174, s11, v105
    v_dot2_f32_bf16 v106, v175, s10, v106
    v_dot2_f32_bf16 v107, v175, s11, v107
    s_waitcnt vmcnt(22)
    v_dot2_f32_bf16 v100, v176, s10, v100
    v_dot2_f32_bf16 v101, v176, s11, v101
    v_dot2_f32_bf16 v102, v177, s10, v102
    v_dot2_f32_bf16 v103, v177, s11, v103
    v_dot2_f32_bf16 v104, v178, s10, v104
    v_dot2_f32_bf16 v105, v178, s11, v105
    v_dot2_f32_bf16 v106, v179, s10, v106
    v_dot2_f32_bf16 v107, v179, s11, v107
    buffer_load_dwordx4 v[122:125], v33, s[60:63], s23 offen offset:0 nt
    buffer_load_dwordx4 v[56:59], v33, s[60:63], s23 offen offset:1024 nt
    v_accvgpr_read_b32 v23, a241
    buffer_load_dwordx2 v[120:121], v23, s[60:63], 0 offen
    buffer_load_dwordx2 v[54:55], v33, s[60:63], s23 offen offset:1016
    s_waitcnt vmcnt(25)
    v_dot2_f32_bf16 v100, v180, s10, v100
    v_dot2_f32_bf16 v101, v180, s11, v101
    v_dot2_f32_bf16 v102, v181, s10, v102
    v_dot2_f32_bf16 v103, v181, s11, v103
    v_dot2_f32_bf16 v104, v182, s10, v104
    v_dot2_f32_bf16 v105, v182, s11, v105
    v_dot2_f32_bf16 v106, v183, s10, v106
    v_dot2_f32_bf16 v107, v183, s11, v107
    s_waitcnt vmcnt(24)
    v_dot2_f32_bf16 v100, v184, s10, v100
    v_dot2_f32_bf16 v101, v184, s11, v101
    v_dot2_f32_bf16 v102, v185, s10, v102
    v_dot2_f32_bf16 v103, v185, s11, v103
    v_dot2_f32_bf16 v104, v186, s10, v104
    v_dot2_f32_bf16 v105, v186, s11, v105
    v_dot2_f32_bf16 v106, v187, s10, v106
    v_dot2_f32_bf16 v107, v187, s11, v107
    s_waitcnt vmcnt(23)
    v_dot2_f32_bf16 v100, v188, s10, v100
    v_dot2_f32_bf16 v101, v188, s11, v101
    v_dot2_f32_bf16 v102, v189, s10, v102
    v_dot2_f32_bf16 v103, v189, s11, v103
    v_dot2_f32_bf16 v104, v190, s10, v104
    v_dot2_f32_bf16 v105, v190, s11, v105
    v_dot2_f32_bf16 v106, v191, s10, v106
    v_dot2_f32_bf16 v107, v191, s11, v107
    s_waitcnt vmcnt(22)
    v_dot2_f32_bf16 v100, v192, s10, v100
    v_dot2_f32_bf16 v101, v192, s11, v101
    v_dot2_f32_bf16 v102, v193, s10, v102
    v_dot2_f32_bf16 v103, v193, s11, v103
    v_dot2_f32_bf16 v104, v194, s10, v104
    v_dot2_f32_bf16 v105, v194, s11, v105
    v_dot2_f32_bf16 v106, v195, s10, v106
    v_dot2_f32_bf16 v107, v195, s11, v107
    s_waitcnt vmcnt(21)
    v_dot2_f32_bf16 v100, v196, s10, v100
    v_dot2_f32_bf16 v101, v196, s11, v101
    v_dot2_f32_bf16 v102, v197, s10, v102
    v_dot2_f32_bf16 v103, v197, s11, v103
    v_dot2_f32_bf16 v104, v198, s10, v104
    v_dot2_f32_bf16 v105, v198, s11, v105
    v_dot2_f32_bf16 v106, v199, s10, v106
    v_dot2_f32_bf16 v107, v199, s11, v107
    s_waitcnt vmcnt(20)
    v_dot2_f32_bf16 v100, v200, s10, v100
    v_dot2_f32_bf16 v101, v200, s11, v101
    v_dot2_f32_bf16 v102, v201, s10, v102
    v_dot2_f32_bf16 v103, v201, s11, v103
    v_dot2_f32_bf16 v104, v202, s10, v104
    v_dot2_f32_bf16 v105, v202, s11, v105
    v_dot2_f32_bf16 v106, v203, s10, v106
    v_dot2_f32_bf16 v107, v203, s11, v107
    s_waitcnt vmcnt(19)
    v_dot2_f32_bf16 v100, v204, s10, v100
    v_dot2_f32_bf16 v101, v204, s11, v101
    v_dot2_f32_bf16 v102, v205, s10, v102
    v_dot2_f32_bf16 v103, v205, s11, v103
    v_dot2_f32_bf16 v104, v206, s10, v104
    v_dot2_f32_bf16 v105, v206, s11, v105
    v_dot2_f32_bf16 v106, v207, s10, v106
    v_dot2_f32_bf16 v107, v207, s11, v107
    s_waitcnt vmcnt(15)
    v_dot2_f32_bf16 v100, v208, s10, v100
    v_dot2_f32_bf16 v101, v208, s11, v101
    v_dot2_f32_bf16 v102, v209, s10, v102
    v_dot2_f32_bf16 v103, v209, s11, v103
    v_dot2_f32_bf16 v104, v210, s10, v104
    v_dot2_f32_bf16 v105, v210, s11, v105
    v_dot2_f32_bf16 v106, v211, s10, v106
    v_dot2_f32_bf16 v107, v211, s11, v107
    s_mov_b64 exec, 0x1
    buffer_store_dword v31, v32, s[76:79], s81 offen sc1
    s_mov_b64 exec, -1
    s_waitcnt vmcnt(15)
    v_dot2_f32_bf16 v100, v212, s10, v100
    v_dot2_f32_bf16 v101, v212, s11, v101
    v_dot2_f32_bf16 v102, v213, s10, v102
    v_dot2_f32_bf16 v103, v213, s11, v103
    v_dot2_f32_bf16 v104, v214, s10, v104
    v_dot2_f32_bf16 v105, v214, s11, v105
    v_dot2_f32_bf16 v106, v215, s10, v106
    v_dot2_f32_bf16 v107, v215, s11, v107
    s_waitcnt vmcnt(14)
    v_dot2_f32_bf16 v100, v216, s10, v100
    v_dot2_f32_bf16 v101, v216, s11, v101
    v_dot2_f32_bf16 v102, v217, s10, v102
    v_dot2_f32_bf16 v103, v217, s11, v103
    v_dot2_f32_bf16 v104, v218, s10, v104
    v_dot2_f32_bf16 v105, v218, s11, v105
    v_dot2_f32_bf16 v106, v219, s10, v106
    v_dot2_f32_bf16 v107, v219, s11, v107
    s_waitcnt vmcnt(13)
    v_dot2_f32_bf16 v100, v220, s10, v100
    v_dot2_f32_bf16 v101, v220, s11, v101
    v_dot2_f32_bf16 v102, v221, s10, v102
    v_dot2_f32_bf16 v103, v221, s11, v103
    v_dot2_f32_bf16 v104, v222, s10, v104
    v_dot2_f32_bf16 v105, v222, s11, v105
    v_dot2_f32_bf16 v106, v223, s10, v106
    v_dot2_f32_bf16 v107, v223, s11, v107
    s_waitcnt vmcnt(12)
    v_dot2_f32_bf16 v100, v224, s10, v100
    v_dot2_f32_bf16 v101, v224, s11, v101
    v_dot2_f32_bf16 v102, v225, s10, v102
    v_dot2_f32_bf16 v103, v225, s11, v103
    v_dot2_f32_bf16 v104, v226, s10, v104
    v_dot2_f32_bf16 v105, v226, s11, v105
    v_dot2_f32_bf16 v106, v227, s10, v106
    v_dot2_f32_bf16 v107, v227, s11, v107
    s_waitcnt vmcnt(11)
    v_dot2_f32_bf16 v100, v228, s10, v100
    v_dot2_f32_bf16 v101, v228, s11, v101
    v_dot2_f32_bf16 v102, v229, s10, v102
    v_dot2_f32_bf16 v103, v229, s11, v103
    v_dot2_f32_bf16 v104, v230, s10, v104
    v_dot2_f32_bf16 v105, v230, s11, v105
    v_dot2_f32_bf16 v106, v231, s10, v106
    v_dot2_f32_bf16 v107, v231, s11, v107
    s_waitcnt vmcnt(10)
    v_dot2_f32_bf16 v100, v232, s10, v100
    v_dot2_f32_bf16 v101, v232, s11, v101
    v_dot2_f32_bf16 v102, v233, s10, v102
    v_dot2_f32_bf16 v103, v233, s11, v103
    v_dot2_f32_bf16 v104, v234, s10, v104
    v_dot2_f32_bf16 v105, v234, s11, v105
    v_dot2_f32_bf16 v106, v235, s10, v106
    v_dot2_f32_bf16 v107, v235, s11, v107
    s_waitcnt vmcnt(9)
    v_dot2_f32_bf16 v100, v236, s10, v100
    v_dot2_f32_bf16 v101, v236, s11, v101
    v_dot2_f32_bf16 v102, v237, s10, v102
    v_dot2_f32_bf16 v103, v237, s11, v103
    v_dot2_f32_bf16 v104, v238, s10, v104
    v_dot2_f32_bf16 v105, v238, s11, v105
    v_dot2_f32_bf16 v106, v239, s10, v106
    v_dot2_f32_bf16 v107, v239, s11, v107
    s_waitcnt vmcnt(8)
    v_dot2_f32_bf16 v100, v240, s10, v100
    v_dot2_f32_bf16 v101, v240, s11, v101
    v_dot2_f32_bf16 v102, v241, s10, v102
    v_dot2_f32_bf16 v103, v241, s11, v103
    v_dot2_f32_bf16 v104, v242, s10, v104
    v_dot2_f32_bf16 v105, v242, s11, v105
    v_dot2_f32_bf16 v106, v243, s10, v106
    v_dot2_f32_bf16 v107, v243, s11, v107
    s_waitcnt vmcnt(7)
    v_dot2_f32_bf16 v100, v244, s10, v100
    v_dot2_f32_bf16 v101, v244, s11, v101
    v_dot2_f32_bf16 v102, v245, s10, v102
    v_dot2_f32_bf16 v103, v245, s11, v103
    v_dot2_f32_bf16 v104, v246, s10, v104
    v_dot2_f32_bf16 v105, v246, s11, v105
    v_dot2_f32_bf16 v106, v247, s10, v106
    v_dot2_f32_bf16 v107, v247, s11, v107
    s_waitcnt vmcnt(6)
    v_dot2_f32_bf16 v100, v248, s10, v100
    v_dot2_f32_bf16 v101, v248, s11, v101
    v_dot2_f32_bf16 v102, v249, s10, v102
    v_dot2_f32_bf16 v103, v249, s11, v103
    v_dot2_f32_bf16 v104, v250, s10, v104
    v_dot2_f32_bf16 v105, v250, s11, v105
    v_dot2_f32_bf16 v106, v251, s10, v106
    v_dot2_f32_bf16 v107, v251, s11, v107
    s_waitcnt vmcnt(5)
    v_dot2_f32_bf16 v100, v252, s10, v100
    v_dot2_f32_bf16 v101, v252, s11, v101
    v_dot2_f32_bf16 v102, v253, s10, v102
    v_dot2_f32_bf16 v103, v253, s11, v103
    v_dot2_f32_bf16 v104, v254, s10, v104
    v_dot2_f32_bf16 v105, v254, s11, v105
    v_dot2_f32_bf16 v106, v255, s10, v106
    v_dot2_f32_bf16 v107, v255, s11, v107
    s_lshl_b32 s10, s3, 11
    s_add_u32 s10, s10, 152320
    v_lshl_add_u32 v2, v0, 5, s10
    ds_write_b128 v2, v[100:103]
    ds_write_b128 v2, v[104:107] offset:16
    s_waitcnt lgkmcnt(0)
    s_barrier
    s_and_b32 s10, s3, 1
    s_lshl_b32 s10, s10, 6
    v_add_u32 v2, s10, v0
    v_lshlrev_b32 v3, 2, v2
    v_add_u32 v3, 152320, v3
    ds_read_b32 v128, v3 offset:0
    ds_read_b32 v129, v3 offset:512
    ds_read_b32 v130, v3 offset:1024
    ds_read_b32 v131, v3 offset:1536
    ds_read_b32 v132, v3 offset:2048
    ds_read_b32 v133, v3 offset:2560
    ds_read_b32 v134, v3 offset:3072
    ds_read_b32 v135, v3 offset:3584
    ds_read_b32 v136, v3 offset:4096
    ds_read_b32 v137, v3 offset:4608
    ds_read_b32 v138, v3 offset:5120
    ds_read_b32 v139, v3 offset:5632
    ds_read_b32 v140, v3 offset:6144
    ds_read_b32 v141, v3 offset:6656
    ds_read_b32 v142, v3 offset:7168
    ds_read_b32 v143, v3 offset:7680
    s_waitcnt lgkmcnt(7)
    v_add_f32 v128, v128, v136
    s_waitcnt lgkmcnt(6)
    v_add_f32 v129, v129, v137
    s_waitcnt lgkmcnt(5)
    v_add_f32 v130, v130, v138
    s_waitcnt lgkmcnt(4)
    v_add_f32 v131, v131, v139
    s_waitcnt lgkmcnt(3)
    v_add_f32 v132, v132, v140
    s_waitcnt lgkmcnt(2)
    v_add_f32 v133, v133, v141
    s_waitcnt lgkmcnt(1)
    v_add_f32 v134, v134, v142
    s_waitcnt lgkmcnt(0)
    v_add_f32 v135, v135, v143
    v_add_f32 v128, v128, v132
    v_add_f32 v129, v129, v133
    v_add_f32 v130, v130, v134
    v_add_f32 v131, v131, v135
    v_add_f32 v128, v128, v130
    v_add_f32 v129, v129, v131
    v_add_f32 v128, v128, v129
    v_cvt_pk_bf16_f32 v129, v128, v128
    v_lshlrev_b32 v129, 16, v129
    v_sub_f32 v129, v128, v129
    v_cvt_pk_bf16_f32 v128, v128, v129
    v_and_b32 v3, 15, v2
    v_lshlrev_b32 v3, 5, v3
    v_lshrrev_b32 v2, 4, v2
    v_lshl_add_u32 v3, v2, 2, v3
    s_lshr_b32 s10, s3, 1
    s_lshl_b32 s10, s10, 24
    v_add_u32 v3, s10, v3
    s_and_b32 s9, s4, 1
    s_lshl_b32 s10, s18, 1
    s_add_u32 s9, s9, s10
    s_lshl_b32 s10, s9, 9
    s_add_u32 s10, s10, 12648448
    buffer_store_dword v128, v3, s[76:79], s10 offen sc1
    s_lshl_b32 s9, s9, 7
    s_add_u32 s9, s9, 12730368
    s_mov_b32 s19, s40
    s_add_u32 s40, s19, 0
    s_add_u32 m0, s14, 0
    s_nop 0
    buffer_load_dwordx4 v36, s[68:71], s40 offen offset:0 lds
    buffer_load_dwordx4 v37, s[68:71], s40 offen offset:1024 lds
    s_add_u32 s40, s40, 16384
    s_add_u32 m0, s14, 2048
    s_nop 0
    buffer_load_dwordx4 v36, s[68:71], s40 offen offset:0 lds
    buffer_load_dwordx4 v37, s[68:71], s40 offen offset:1024 lds
    s_add_u32 s40, s40, 16384
    s_add_u32 m0, s14, 4096
    s_nop 0
    buffer_load_dwordx4 v36, s[68:71], s40 offen offset:0 lds
    buffer_load_dwordx4 v37, s[68:71], s40 offen offset:1024 lds
    s_add_u32 s40, s40, 16384
    s_add_u32 m0, s14, 6144
    s_nop 0
    buffer_load_dwordx4 v36, s[68:71], s40 offen offset:0 lds
    buffer_load_dwordx4 v37, s[68:71], s40 offen offset:1024 lds
    s_add_u32 s40, s40, 16384
    s_waitcnt vmcnt(8)
    s_barrier
    s_mov_b64 exec, 0x1
    buffer_store_dword v31, v32, s[76:79], s9 offen sc1
    s_mov_b64 exec, -1
    v_mov_b32 v34, s12
    s_mov_b32 exec_hi, 0
    buffer_load_dword v34, v35, s[76:79], s85 offen sc1
    s_mov_b32 exec_hi, -1
    v_accvgpr_read_b32 v21, a240
    v_mov_b32 v60, 0
    v_mov_b32 v61, 0
    v_mov_b32 v62, 0
    v_mov_b32 v63, 0
    ds_write_b128 v21, v[60:63]
    ds_write_b128 v27, v[122:125] offset:13536
    v_alignbit_b32 v64, v121, v120, 16
    v_alignbit_b32 v65, v122, v121, 16
    v_alignbit_b32 v66, v123, v122, 16
    v_alignbit_b32 v67, v124, v123, 16
    ds_write_b128 v27, v[64:67] offset:0
    v_mov_b32 v68, v121
    v_mov_b32 v69, v122
    v_mov_b32 v70, v123
    v_mov_b32 v71, v124
    ds_write_b128 v27, v[68:71] offset:4512
    v_alignbit_b32 v72, v122, v121, 16
    v_alignbit_b32 v73, v123, v122, 16
    v_alignbit_b32 v74, v124, v123, 16
    v_alignbit_b32 v75, v125, v124, 16
    ds_write_b128 v27, v[72:75] offset:9024
    ds_write_b128 v27, v[56:59] offset:14560
    v_alignbit_b32 v76, v55, v54, 16
    v_alignbit_b32 v77, v56, v55, 16
    v_alignbit_b32 v78, v57, v56, 16
    v_alignbit_b32 v79, v58, v57, 16
    ds_write_b128 v27, v[76:79] offset:1024
    v_mov_b32 v80, v55
    v_mov_b32 v81, v56
    v_mov_b32 v82, v57
    v_mov_b32 v83, v58
    ds_write_b128 v27, v[80:83] offset:5536
    v_alignbit_b32 v84, v56, v55, 16
    v_alignbit_b32 v85, v57, v56, 16
    v_alignbit_b32 v86, v58, v57, 16
    v_alignbit_b32 v87, v59, v58, 16
    ds_write_b128 v27, v[84:87] offset:10048
    s_waitcnt vmcnt(0)
    v_cmp_ne_u32 vcc, s12, v34
    s_nop 1
    s_cbranch_vccnz L_slow2
L_back2:
    s_add_u32 s23, s23, 8388608
    buffer_load_dwordx4 v[40:43], v33, s[76:79], s23 offen sc1
    buffer_load_dwordx4 v[44:47], v33, s[76:79], s23 offen offset:1024 sc1
    s_add_u32 s40, s19, 65536
    s_add_u32 m0, s14, 8192
    s_nop 0
    buffer_load_dwordx4 v36, s[68:71], s40 offen offset:0 lds
    buffer_load_dwordx4 v37, s[68:71], s40 offen offset:1024 lds
    s_add_u32 s40, s40, 16384
    s_add_u32 m0, s14, 10240
    s_nop 0
    buffer_load_dwordx4 v36, s[68:71], s40 offen offset:0 lds
    buffer_load_dwordx4 v37, s[68:71], s40 offen offset:1024 lds
    s_add_u32 s40, s40, 16384
    s_add_u32 m0, s14, 12288
    s_nop 0
    buffer_load_dwordx4 v36, s[68:71], s40 offen offset:0 lds
    buffer_load_dwordx4 v37, s[68:71], s40 offen offset:1024 lds
    s_add_u32 s40, s40, 16384
    s_add_u32 m0, s14, 14336
    s_nop 0
    buffer_load_dwordx4 v36, s[68:71], s40 offen offset:0 lds
    buffer_load_dwordx4 v37, s[68:71], s40 offen offset:1024 lds
    s_add_u32 s40, s40, 16384
    ds_write_b64 v28, v[60:61]
    s_waitcnt vmcnt(9)
    ds_write_b128 v29, v[40:43] offset:0
    ds_write_b64 v29, v[40:41] offset:4216
    ds_write_b64 v29, v[42:43] offset:4224
    s_waitcnt vmcnt(8)
    ds_write_b128 v29, v[44:47] offset:1024
    ds_write_b64 v29, v[44:45] offset:5240
    ds_write_b64 v29, v[46:47] offset:5248
    s_waitcnt lgkmcnt(0)
    s_barrier
    v_accvgpr_read_b32 v1, a243
    v_accvgpr_read_b32 v2, a244
    v_accvgpr_read_b32 v3, a245
    v_accvgpr_read_b32 v4, a246
    v_accvgpr_read_b32 v5, a247
    v_accvgpr_read_b32 v35, a248
    v_accvgpr_read_b32 v28, a249
    v_accvgpr_read_b32 v29, a224
    ds_read_b128 v[64:67], v1 offset:192
    ds_read_b128 v[96:99], v2 offset:3776
    ds_read_b128 v[68:71], v1 offset:704
    ds_read_b128 v[100:103], v2 offset:3264
    ds_read_b128 v[72:75], v1 offset:1216
    ds_read_b128 v[104:107], v2 offset:2752
    ds_read_b128 v[76:79], v1 offset:1728
    ds_read_b128 v[108:111], v2 offset:2240
    ds_read_b128 v[80:83], v1 offset:2240
    ds_read_b128 v[112:115], v2 offset:1728
    ds_read_b128 v[84:87], v1 offset:2752
    ds_read_b128 v[116:119], v2 offset:1216
    ds_read_b128 v[88:91], v1 offset:3264
    ds_read_b128 v[120:123], v2 offset:704
    ds_read_b128 v[92:95], v1 offset:3776
    ds_read_b128 v[124:127], v2 offset:192
    s_waitcnt lgkmcnt(14)
    v_mfma_f32_16x16x32_bf16 v[8:11], v[64:67], v[96:99], 0
    s_waitcnt lgkmcnt(12)
    v_mfma_f32_16x16x32_bf16 v[12:15], v[64:67], v[100:103], 0
    ds_read_b128 v[128:131], v1 offset:128
    v_mfma_f32_16x16x32_bf16 v[12:15], v[68:71], v[96:99], v[12:15]
    s_add_u32 s40, s19, 131072
    s_add_u32 m0, s14, 16384
    s_nop 0
    buffer_load_dwordx4 v36, s[68:71], s40 offen offset:0 lds
    v_mfma_f32_16x16x32_bf16 v[16:19], v[68:71], v[100:103], 0
    ds_read_b128 v[160:163], v2 offset:3712
    s_waitcnt lgkmcnt(12)
    v_mfma_f32_16x16x32_bf16 v[16:19], v[64:67], v[104:107], v[16:19]
    v_mfma_f32_16x16x32_bf16 v[16:19], v[72:75], v[96:99], v[16:19]
    ds_read_b128 v[132:135], v1 offset:640
    v_mfma_f32_16x16x32_bf16 v[20:23], v[68:71], v[104:107], 0
    buffer_load_dwordx4 v37, s[68:71], s40 offen offset:1024 lds
    v_mfma_f32_16x16x32_bf16 v[20:23], v[72:75], v[100:103], v[20:23]
    ds_read_b128 v[164:167], v2 offset:3200
    v_mfma_f32_16x16x32_bf16 v[48:51], v[72:75], v[104:107], 0
    s_waitcnt lgkmcnt(12)
    v_mfma_f32_16x16x32_bf16 v[20:23], v[64:67], v[108:111], v[20:23]
    ds_read_b128 v[136:139], v1 offset:1152
    v_mfma_f32_16x16x32_bf16 v[20:23], v[76:79], v[96:99], v[20:23]
    s_add_u32 s40, s40, 16384
    s_add_u32 m0, s14, 18432
    s_nop 0
    buffer_load_dwordx4 v36, s[68:71], s40 offen offset:0 lds
    v_mfma_f32_16x16x32_bf16 v[48:51], v[68:71], v[108:111], v[48:51]
    ds_read_b128 v[168:171], v2 offset:2688
    v_mfma_f32_16x16x32_bf16 v[48:51], v[76:79], v[100:103], v[48:51]
    v_mfma_f32_16x16x32_bf16 v[52:55], v[72:75], v[108:111], 0
    ds_read_b128 v[140:143], v1 offset:1664
    v_mfma_f32_16x16x32_bf16 v[52:55], v[76:79], v[104:107], v[52:55]
    buffer_load_dwordx4 v37, s[68:71], s40 offen offset:1024 lds
    v_mfma_f32_16x16x32_bf16 v[56:59], v[76:79], v[108:111], 0
    ds_read_b128 v[172:175], v2 offset:2176
    s_waitcnt lgkmcnt(14)
    v_mfma_f32_16x16x32_bf16 v[48:51], v[64:67], v[112:115], v[48:51]
    v_mfma_f32_16x16x32_bf16 v[48:51], v[80:83], v[96:99], v[48:51]
    ds_read_b128 v[144:147], v1 offset:2176
    v_mfma_f32_16x16x32_bf16 v[52:55], v[68:71], v[112:115], v[52:55]
    s_add_u32 s40, s40, 16384
    s_add_u32 m0, s14, 20480
    s_nop 0
    buffer_load_dwordx4 v36, s[68:71], s40 offen offset:0 lds
    v_mfma_f32_16x16x32_bf16 v[52:55], v[80:83], v[100:103], v[52:55]
    ds_read_b128 v[176:179], v2 offset:1664
    v_mfma_f32_16x16x32_bf16 v[56:59], v[72:75], v[112:115], v[56:59]
    v_mfma_f32_16x16x32_bf16 v[56:59], v[80:83], v[104:107], v[56:59]
    ds_read_b128 v[148:151], v1 offset:2688
    v_mfma_f32_16x16x32_bf16 v[60:63], v[76:79], v[112:115], 0
    buffer_load_dwordx4 v37, s[68:71], s40 offen offset:1024 lds
    v_mfma_f32_16x16x32_bf16 v[60:63], v[80:83], v[108:111], v[60:63]
    ds_read_b128 v[180:183], v2 offset:1152
    s_waitcnt lgkmcnt(15)
    v_mfma_f32_16x16x32_bf16 v[52:55], v[64:67], v[116:119], v[52:55]
    v_mfma_f32_16x16x32_bf16 v[52:55], v[84:87], v[96:99], v[52:55]
    ds_read_b128 v[152:155], v1 offset:3200
    v_mfma_f32_16x16x32_bf16 v[56:59], v[68:71], v[116:119], v[56:59]
    s_add_u32 s40, s40, 16384
    s_add_u32 m0, s14, 22528
    s_nop 0
    buffer_load_dwordx4 v36, s[68:71], s40 offen offset:0 lds
    v_mfma_f32_16x16x32_bf16 v[56:59], v[84:87], v[100:103], v[56:59]
    ds_read_b128 v[184:187], v2 offset:640
    v_mfma_f32_16x16x32_bf16 v[60:63], v[72:75], v[116:119], v[60:63]
    v_mfma_f32_16x16x32_bf16 v[60:63], v[84:87], v[104:107], v[60:63]
    ds_read_b128 v[156:159], v1 offset:3712
    s_waitcnt lgkmcnt(15)
    v_mfma_f32_16x16x32_bf16 v[56:59], v[64:67], v[120:123], v[56:59]
    buffer_load_dwordx4 v37, s[68:71], s40 offen offset:1024 lds
    s_add_u32 s40, s40, 16384
    v_mfma_f32_16x16x32_bf16 v[56:59], v[88:91], v[96:99], v[56:59]
    ds_read_b128 v[188:191], v2 offset:128
    v_mfma_f32_16x16x32_bf16 v[60:63], v[68:71], v[120:123], v[60:63]
    v_mfma_f32_16x16x32_bf16 v[60:63], v[88:91], v[100:103], v[60:63]
    v_mfma_f32_16x16x32_bf16 v[60:63], v[64:67], v[124:127], v[60:63]
    v_mfma_f32_16x16x32_bf16 v[60:63], v[92:95], v[96:99], v[60:63]
    s_waitcnt lgkmcnt(14)
    v_mfma_f32_16x16x32_bf16 v[8:11], v[128:131], v[160:163], v[8:11]
    s_waitcnt lgkmcnt(12)
    v_mfma_f32_16x16x32_bf16 v[12:15], v[128:131], v[164:167], v[12:15]
    ds_read_b128 v[64:67], v1 offset:64
    ds_read_b64_tr_b16 a[96:97], v4 offset:0
    v_mfma_f32_16x16x32_bf16 v[12:15], v[132:135], v[160:163], v[12:15]
    ds_read_b64_tr_b16 a[98:99], v4 offset:1024
    v_mfma_f32_16x16x32_bf16 v[16:19], v[132:135], v[164:167], v[16:19]
    ds_read_b128 v[96:99], v2 offset:3648
    ds_read_b64_tr_b16 a[100:101], v5 offset:0
    s_waitcnt lgkmcnt(15)
    v_mfma_f32_16x16x32_bf16 v[16:19], v[128:131], v[168:171], v[16:19]
    ds_read_b64_tr_b16 a[102:103], v5 offset:1024
    v_mfma_f32_16x16x32_bf16 v[16:19], v[136:139], v[160:163], v[16:19]
    ds_read_b128 v[68:71], v1 offset:576
    ds_read_b64_tr_b16 a[104:105], v4 offset:2048
    v_mfma_f32_16x16x32_bf16 v[20:23], v[132:135], v[168:171], v[20:23]
    ds_read_b64_tr_b16 a[106:107], v4 offset:3072
    v_mfma_f32_16x16x32_bf16 v[20:23], v[136:139], v[164:167], v[20:23]
    ds_read_b128 v[100:103], v2 offset:3136
    ds_read_b64_tr_b16 a[108:109], v5 offset:2048
    v_mfma_f32_16x16x32_bf16 v[48:51], v[136:139], v[168:171], v[48:51]
    ds_read_b64_tr_b16 a[110:111], v5 offset:3072
    s_waitcnt lgkmcnt(15)
    v_mfma_f32_16x16x32_bf16 v[20:23], v[128:131], v[172:175], v[20:23]
    ds_read_b128 v[72:75], v1 offset:1088
    ds_read_b64_tr_b16 a[112:113], v4 offset:4096
    v_mfma_f32_16x16x32_bf16 v[20:23], v[140:143], v[160:163], v[20:23]
    ds_read_b64_tr_b16 a[114:115], v4 offset:5120
    v_mfma_f32_16x16x32_bf16 v[48:51], v[132:135], v[172:175], v[48:51]
    ds_read_b128 v[104:107], v2 offset:2624
    ds_read_b64_tr_b16 a[116:117], v5 offset:4096
    v_mfma_f32_16x16x32_bf16 v[48:51], v[140:143], v[164:167], v[48:51]
    ds_read_b64_tr_b16 a[118:119], v5 offset:5120
    v_mfma_f32_16x16x32_bf16 v[52:55], v[136:139], v[172:175], v[52:55]
    ds_read_b128 v[76:79], v1 offset:1600
    ds_read_b64_tr_b16 a[120:121], v4 offset:6144
    v_mfma_f32_16x16x32_bf16 v[52:55], v[140:143], v[168:171], v[52:55]
    ds_read_b64_tr_b16 a[122:123], v4 offset:7168
    v_mfma_f32_16x16x32_bf16 v[56:59], v[140:143], v[172:175], v[56:59]
    ds_read_b128 v[108:111], v2 offset:2112
    ds_read_b64_tr_b16 a[124:125], v5 offset:6144
    v_mfma_f32_16x16x32_bf16 v[48:51], v[128:131], v[176:179], v[48:51]
    ds_read_b64_tr_b16 a[126:127], v5 offset:7168
    v_mfma_f32_16x16x32_bf16 v[48:51], v[144:147], v[160:163], v[48:51]
    ds_read_b128 v[80:83], v1 offset:2112
    v_mfma_f32_16x16x32_bf16 v[52:55], v[132:135], v[176:179], v[52:55]
    v_mfma_f32_16x16x32_bf16 v[52:55], v[144:147], v[164:167], v[52:55]
    ds_read_b128 v[112:115], v2 offset:1600
    v_mfma_f32_16x16x32_bf16 v[56:59], v[136:139], v[176:179], v[56:59]
    v_mfma_f32_16x16x32_bf16 v[56:59], v[144:147], v[168:171], v[56:59]
    ds_read_b128 v[84:87], v1 offset:2624
    v_mfma_f32_16x16x32_bf16 v[60:63], v[140:143], v[176:179], v[60:63]
    s_waitcnt lgkmcnt(3)
    s_add_u32 s40, s19, 196608
    s_add_u32 m0, s14, 0
    s_nop 0
    buffer_load_dwordx4 v36, s[68:71], s40 offen offset:0 lds
    v_mfma_f32_16x16x32_bf16 v[60:63], v[144:147], v[172:175], v[60:63]
    ds_read_b128 v[116:119], v2 offset:1088
    v_mfma_f32_16x16x32_bf16 v[52:55], v[128:131], v[180:183], v[52:55]
    v_mfma_f32_16x16x32_bf16 v[52:55], v[148:151], v[160:163], v[52:55]
    ds_read_b128 v[88:91], v1 offset:3136
    v_mfma_f32_16x16x32_bf16 v[56:59], v[132:135], v[180:183], v[56:59]
    buffer_load_dwordx4 v37, s[68:71], s40 offen offset:1024 lds
    v_mfma_f32_16x16x32_bf16 v[56:59], v[148:151], v[164:167], v[56:59]
    ds_read_b128 v[120:123], v2 offset:576
    v_mfma_f32_16x16x32_bf16 v[60:63], v[136:139], v[180:183], v[60:63]
    v_mfma_f32_16x16x32_bf16 v[60:63], v[148:151], v[168:171], v[60:63]
    ds_read_b128 v[92:95], v1 offset:3648
    v_mfma_f32_16x16x32_bf16 v[56:59], v[128:131], v[184:187], v[56:59]
    s_add_u32 s40, s40, 16384
    s_add_u32 m0, s14, 2048
    s_nop 0
    buffer_load_dwordx4 v36, s[68:71], s40 offen offset:0 lds
    v_mfma_f32_16x16x32_bf16 v[56:59], v[152:155], v[160:163], v[56:59]
    ds_read_b128 v[124:127], v2 offset:64
    v_mfma_f32_16x16x32_bf16 v[60:63], v[132:135], v[184:187], v[60:63]
    v_mfma_f32_16x16x32_bf16 v[60:63], v[152:155], v[164:167], v[60:63]
    v_mfma_f32_16x16x32_bf16 v[60:63], v[128:131], v[188:191], v[60:63]
    buffer_load_dwordx4 v37, s[68:71], s40 offen offset:1024 lds
    v_mfma_f32_16x16x32_bf16 v[60:63], v[156:159], v[160:163], v[60:63]
    v_mfma_f32_16x16x32_bf16 v[8:11], v[64:67], v[96:99], v[8:11]
    v_mfma_f32_16x16x32_bf16 v[12:15], v[64:67], v[100:103], v[12:15]
    ds_read_b128 v[128:131], v1 offset:0
    v_mfma_f32_16x16x32_bf16 v[12:15], v[68:71], v[96:99], v[12:15]
    s_add_u32 s40, s40, 16384
    s_add_u32 m0, s14, 4096
    s_nop 0
    buffer_load_dwordx4 v36, s[68:71], s40 offen offset:0 lds
    v_mfma_f32_16x16x32_bf16 v[16:19], v[68:71], v[100:103], v[16:19]
    ds_read_b128 v[160:163], v2 offset:3584
    v_mfma_f32_16x16x32_bf16 v[16:19], v[64:67], v[104:107], v[16:19]
    v_mfma_f32_16x16x32_bf16 v[16:19], v[72:75], v[96:99], v[16:19]
    ds_read_b128 v[132:135], v1 offset:512
    v_mfma_f32_16x16x32_bf16 v[20:23], v[68:71], v[104:107], v[20:23]
    buffer_load_dwordx4 v37, s[68:71], s40 offen offset:1024 lds
    v_mfma_f32_16x16x32_bf16 v[20:23], v[72:75], v[100:103], v[20:23]
    ds_read_b128 v[164:167], v2 offset:3072
    v_mfma_f32_16x16x32_bf16 v[48:51], v[72:75], v[104:107], v[48:51]
    v_mfma_f32_16x16x32_bf16 v[20:23], v[64:67], v[108:111], v[20:23]
    ds_read_b128 v[136:139], v1 offset:1024
    v_mfma_f32_16x16x32_bf16 v[20:23], v[76:79], v[96:99], v[20:23]
    s_add_u32 s40, s40, 16384
    s_add_u32 m0, s14, 6144
    s_nop 0
    buffer_load_dwordx4 v36, s[68:71], s40 offen offset:0 lds
    v_mfma_f32_16x16x32_bf16 v[48:51], v[68:71], v[108:111], v[48:51]
    ds_read_b128 v[168:171], v2 offset:2560
    v_mfma_f32_16x16x32_bf16 v[48:51], v[76:79], v[100:103], v[48:51]
    v_mfma_f32_16x16x32_bf16 v[52:55], v[72:75], v[108:111], v[52:55]
    ds_read_b128 v[140:143], v1 offset:1536
    v_mfma_f32_16x16x32_bf16 v[52:55], v[76:79], v[104:107], v[52:55]
    buffer_load_dwordx4 v37, s[68:71], s40 offen offset:1024 lds
    s_add_u32 s40, s40, 16384
    v_mfma_f32_16x16x32_bf16 v[56:59], v[76:79], v[108:111], v[56:59]
    ds_read_b128 v[172:175], v2 offset:2048
    s_waitcnt lgkmcnt(14)
    v_mfma_f32_16x16x32_bf16 v[48:51], v[64:67], v[112:115], v[48:51]
    v_mfma_f32_16x16x32_bf16 v[48:51], v[80:83], v[96:99], v[48:51]
    ds_read_b128 v[144:147], v1 offset:2048
    v_mfma_f32_16x16x32_bf16 v[52:55], v[68:71], v[112:115], v[52:55]
    v_mfma_f32_16x16x32_bf16 v[52:55], v[80:83], v[100:103], v[52:55]
    ds_read_b128 v[176:179], v2 offset:1536
    v_mfma_f32_16x16x32_bf16 v[56:59], v[72:75], v[112:115], v[56:59]
    v_mfma_f32_16x16x32_bf16 v[56:59], v[80:83], v[104:107], v[56:59]
    ds_read_b128 v[148:151], v1 offset:2560
    v_mfma_f32_16x16x32_bf16 v[60:63], v[76:79], v[112:115], v[60:63]
    v_mfma_f32_16x16x32_bf16 v[60:63], v[80:83], v[108:111], v[60:63]
    ds_read_b128 v[180:183], v2 offset:1024
    s_waitcnt lgkmcnt(15)
    v_mfma_f32_16x16x32_bf16 v[52:55], v[64:67], v[116:119], v[52:55]
    v_mfma_f32_16x16x32_bf16 v[52:55], v[84:87], v[96:99], v[52:55]
    ds_read_b128 v[152:155], v1 offset:3072
    v_mfma_f32_16x16x32_bf16 v[56:59], v[68:71], v[116:119], v[56:59]
    v_mfma_f32_16x16x32_bf16 v[56:59], v[84:87], v[100:103], v[56:59]
    ds_read_b128 v[184:187], v2 offset:512
    v_mfma_f32_16x16x32_bf16 v[60:63], v[72:75], v[116:119], v[60:63]
    v_mfma_f32_16x16x32_bf16 v[60:63], v[84:87], v[104:107], v[60:63]
    ds_read_b128 v[156:159], v1 offset:3584
    s_waitcnt lgkmcnt(15)
    v_mfma_f32_16x16x32_bf16 v[56:59], v[64:67], v[120:123], v[56:59]
    v_mfma_f32_16x16x32_bf16 v[56:59], v[88:91], v[96:99], v[56:59]
    ds_read_b128 v[188:191], v2 offset:0
    v_mfma_f32_16x16x32_bf16 v[60:63], v[68:71], v[120:123], v[60:63]
    s_lshl_b32 s10, s3, 12
    s_add_u32 s10, s10, 98816
    v_add_u32 v7, s10, v33
    v_lshlrev_b32 v6, 3, v0
    ds_read_b64 v[40:41], v3 offset:1536
    ds_read_b64 v[42:43], v3 offset:1024
    ds_read_b64 v[44:45], v3 offset:512
    ds_read_b64 v[46:47], v3 offset:0
    v_mfma_f32_16x16x32_bf16 v[60:63], v[88:91], v[100:103], v[60:63]
    v_mfma_f32_16x16x32_bf16 v[60:63], v[64:67], v[124:127], v[60:63]
    v_mfma_f32_16x16x32_bf16 v[60:63], v[92:95], v[96:99], v[60:63]
    s_waitcnt lgkmcnt(15)
    v_mfma_f32_16x16x32_bf16 v[8:11], v[128:131], v[160:163], v[8:11]
    v_mfma_f32_16x16x32_bf16 v[12:15], v[128:131], v[164:167], v[12:15]
    v_mfma_f32_16x16x32_bf16 v[12:15], v[132:135], v[160:163], v[12:15]
    v_mfma_f32_16x16x32_bf16 v[16:19], v[132:135], v[164:167], v[16:19]
    s_waitcnt lgkmcnt(14)
    v_mfma_f32_16x16x32_bf16 v[16:19], v[128:131], v[168:171], v[16:19]
    s_waitcnt lgkmcnt(4)
    s_barrier
    v_mfma_f32_16x16x32_bf16 v[16:19], v[136:139], v[160:163], v[16:19]
    s_waitcnt vmcnt(16)
    v_mfma_f32_16x16x32_bf16 v[20:23], v[132:135], v[168:171], v[20:23]
    ds_read_b64_tr_b16 a[128:129], v4 offset:8192
    v_mfma_f32_16x16x32_bf16 v[20:23], v[136:139], v[164:167], v[20:23]
    ds_read_b64_tr_b16 a[130:131], v4 offset:9216
    v_mfma_f32_16x16x32_bf16 v[48:51], v[136:139], v[168:171], v[48:51]
    ds_read_b64_tr_b16 a[132:133], v5 offset:8192
    v_mfma_f32_16x16x32_bf16 v[20:23], v[128:131], v[172:175], v[20:23]
    ds_read_b64_tr_b16 a[134:135], v5 offset:9216
    v_mfma_f32_16x16x32_bf16 v[20:23], v[140:143], v[160:163], v[20:23]
    ds_read_b64_tr_b16 a[136:137], v4 offset:10240
    v_mfma_f32_16x16x32_bf16 v[48:51], v[132:135], v[172:175], v[48:51]
    ds_read_b64_tr_b16 a[138:139], v4 offset:11264
    v_mfma_f32_16x16x32_bf16 v[48:51], v[140:143], v[164:167], v[48:51]
    ds_read_b64_tr_b16 a[140:141], v5 offset:10240
    v_mfma_f32_16x16x32_bf16 v[52:55], v[136:139], v[172:175], v[52:55]
    ds_read_b64_tr_b16 a[142:143], v5 offset:11264
    v_mfma_f32_16x16x32_bf16 v[52:55], v[140:143], v[168:171], v[52:55]
    ds_read_b64_tr_b16 a[144:145], v4 offset:12288
    v_mfma_f32_16x16x32_bf16 v[56:59], v[140:143], v[172:175], v[56:59]
    ds_read_b64_tr_b16 a[146:147], v4 offset:13312
    v_mfma_f32_16x16x32_bf16 v[48:51], v[128:131], v[176:179], v[48:51]
    ds_read_b64_tr_b16 a[148:149], v5 offset:12288
    v_mfma_f32_16x16x32_bf16 v[48:51], v[144:147], v[160:163], v[48:51]
    ds_read_b64_tr_b16 a[150:151], v5 offset:13312
    v_mfma_f32_16x16x32_bf16 v[52:55], v[132:135], v[176:179], v[52:55]
    ds_read_b64_tr_b16 a[152:153], v4 offset:14336
    v_mfma_f32_16x16x32_bf16 v[52:55], v[144:147], v[164:167], v[52:55]
    ds_read_b64_tr_b16 a[154:155], v4 offset:15360
    v_mfma_f32_16x16x32_bf16 v[56:59], v[136:139], v[176:179], v[56:59]
    ds_read_b64_tr_b16 a[156:157], v5 offset:14336
    v_mfma_f32_16x16x32_bf16 v[56:59], v[144:147], v[168:171], v[56:59]
    ds_read_b64_tr_b16 a[158:159], v5 offset:15360
    v_mfma_f32_16x16x32_bf16 v[60:63], v[140:143], v[176:179], v[60:63]
    v_mfma_f32_16x16x32_bf16 v[60:63], v[144:147], v[172:175], v[60:63]
    v_mfma_f32_16x16x32_bf16 v[52:55], v[128:131], v[180:183], v[52:55]
    v_mfma_f32_16x16x32_bf16 v[52:55], v[148:151], v[160:163], v[52:55]
    v_mfma_f32_16x16x32_bf16 v[56:59], v[132:135], v[180:183], v[56:59]
    s_waitcnt lgkmcnt(0)
    s_add_u32 s40, s19, 311296
    s_add_u32 m0, s14, 8192
    s_nop 0
    buffer_load_dwordx4 v36, s[68:71], s40 offen offset:0 lds
    v_mfma_f32_16x16x32_bf16 v[56:59], v[148:151], v[164:167], v[56:59]
    buffer_load_dwordx4 v37, s[68:71], s40 offen offset:1024 lds
    v_mfma_f32_16x16x32_bf16 v[60:63], v[136:139], v[180:183], v[60:63]
    s_add_u32 s40, s40, 16384
    s_add_u32 m0, s14, 10240
    s_nop 0
    buffer_load_dwordx4 v36, s[68:71], s40 offen offset:0 lds
    v_mfma_f32_16x16x32_bf16 v[60:63], v[148:151], v[168:171], v[60:63]
    buffer_load_dwordx4 v37, s[68:71], s40 offen offset:1024 lds
    v_mfma_f32_16x16x32_bf16 v[56:59], v[128:131], v[184:187], v[56:59]
    s_add_u32 s40, s40, 16384
    s_add_u32 m0, s14, 12288
    s_nop 0
    buffer_load_dwordx4 v36, s[68:71], s40 offen offset:0 lds
    v_mfma_f32_16x16x32_bf16 v[56:59], v[152:155], v[160:163], v[56:59]
    buffer_load_dwordx4 v37, s[68:71], s40 offen offset:1024 lds
    v_mfma_f32_16x16x32_bf16 v[60:63], v[132:135], v[184:187], v[60:63]
    s_add_u32 s40, s40, 16384
    s_add_u32 m0, s14, 14336
    s_nop 0
    buffer_load_dwordx4 v36, s[68:71], s40 offen offset:0 lds
    v_mfma_f32_16x16x32_bf16 v[60:63], v[152:155], v[164:167], v[60:63]
    buffer_load_dwordx4 v37, s[68:71], s40 offen offset:1024 lds
    s_add_u32 s40, s40, 16384
    v_mfma_f32_16x16x32_bf16 v[60:63], v[128:131], v[188:191], v[60:63]
    v_mfma_f32_16x16x32_bf16 v[60:63], v[156:159], v[160:163], v[60:63]
    s_bitcmp1_b32 s3, 0
    s_cbranch_scc1 L_xBa
    ds_write_b128 v7, v[48:51] offset:0
    ds_write_b128 v7, v[52:55] offset:1024
    ds_write_b128 v7, v[56:59] offset:2048
    s_nop 2
    ds_write_b128 v7, v[60:63] offset:3072
    s_branch L_xEa
L_xBa:
    ds_write_b128 v7, v[8:11] offset:0
    ds_write_b128 v7, v[12:15] offset:1024
    ds_write_b128 v7, v[16:19] offset:2048
    ds_write_b128 v7, v[20:23] offset:3072
    v_mov_b32 v8, v48
    v_mov_b32 v9, v49
    v_mov_b32 v10, v50
    v_mov_b32 v11, v51
    v_mov_b32 v12, v52
    v_mov_b32 v13, v53
    v_mov_b32 v14, v54
    v_mov_b32 v15, v55
    v_mov_b32 v16, v56
    v_mov_b32 v17, v57
    v_mov_b32 v18, v58
    v_mov_b32 v19, v59
    v_mov_b32 v20, v60
    v_mov_b32 v21, v61
    v_mov_b32 v22, v62
    v_mov_b32 v23, v63
L_xEa:
    v_xor_b32 v7, 0x1000, v7
    v_and_b32 v24, s15, v41
    v_lshlrev_b32 v25, 16, v41
    v_and_b32 v26, s15, v40
    v_lshlrev_b32 v27, 16, v40
    v_fma_f32 v8, s13, v24, v8
    v_fma_f32 v9, s13, v25, v9
    v_fma_f32 v10, s13, v26, v10
    v_fma_f32 v11, s13, v27, v11
    v_and_b32 v24, s15, v43
    v_lshlrev_b32 v25, 16, v43
    v_and_b32 v26, s15, v42
    v_lshlrev_b32 v27, 16, v42
    v_fma_f32 v12, s13, v24, v12
    v_fma_f32 v13, s13, v25, v13
    v_fma_f32 v14, s13, v26, v14
    v_fma_f32 v15, s13, v27, v15
    v_and_b32 v24, s15, v45
    v_lshlrev_b32 v25, 16, v45
    v_and_b32 v26, s15, v44
    v_lshlrev_b32 v27, 16, v44
    v_fma_f32 v16, s13, v24, v16
    v_fma_f32 v17, s13, v25, v17
    v_fma_f32 v18, s13, v26, v18
    v_fma_f32 v19, s13, v27, v19
    v_and_b32 v24, s15, v47
    v_lshlrev_b32 v25, 16, v47
    v_and_b32 v26, s15, v46
    v_lshlrev_b32 v27, 16, v46
    v_fma_f32 v20, s13, v24, v20
    v_fma_f32 v21, s13, v25, v21
    v_fma_f32 v22, s13, v26, v22
    v_fma_f32 v23, s13, v27, v23
    s_waitcnt lgkmcnt(0)
    s_barrier
    ds_read_b128 v[48:51], v7 offset:0
    ds_read_b128 v[52:55], v7 offset:1024
    ds_read_b128 v[56:59], v7 offset:2048
    ds_read_b128 v[60:63], v7 offset:3072
    s_waitcnt lgkmcnt(3)
    v_add_f32 v8, v8, v48
    v_add_f32 v9, v9, v49
    v_add_f32 v10, v10, v50
    v_add_f32 v11, v11, v51
    v_cvt_pk_bf16_f32 v40, v8, v9
    v_cvt_pk_bf16_f32 v41, v10, v11
    s_waitcnt lgkmcnt(2)
    v_add_f32 v12, v12, v52
    v_add_f32 v13, v13, v53
    v_add_f32 v14, v14, v54
    v_add_f32 v15, v15, v55
    v_cvt_pk_bf16_f32 v42, v12, v13
    v_cvt_pk_bf16_f32 v43, v14, v15
    s_waitcnt lgkmcnt(1)
    v_add_f32 v16, v16, v56
    v_add_f32 v17, v17, v57
    v_add_f32 v18, v18, v58
    v_add_f32 v19, v19, v59
    v_cvt_pk_bf16_f32 v44, v16, v17
    v_cvt_pk_bf16_f32 v45, v18, v19
    s_waitcnt lgkmcnt(0)
    v_add_f32 v20, v20, v60
    v_add_f32 v21, v21, v61
    v_add_f32 v22, v22, v62
    v_add_f32 v23, v23, v63
    v_cvt_pk_bf16_f32 v46, v20, v21
    v_cvt_pk_bf16_f32 v47, v22, v23
    buffer_store_dwordx2 v[40:41], v6, s[76:79], s0 offen offset:0 sc1
    buffer_store_dwordx2 v[42:43], v6, s[76:79], s0 offen offset:512 sc1
    buffer_store_dwordx2 v[44:45], v6, s[76:79], s0 offen offset:1024 sc1
    buffer_store_dwordx2 v[46:47], v6, s[76:79], s0 offen offset:1536 sc1
    s_waitcnt vmcnt(20)
    ds_read_b64_tr_b16 a[160:161], v4 offset:16384
    ds_read_b64_tr_b16 a[162:163], v4 offset:17408
    ds_read_b64_tr_b16 a[164:165], v5 offset:16384
    ds_read_b64_tr_b16 a[166:167], v5 offset:17408
    ds_read_b64_tr_b16 a[168:169], v4 offset:18432
    ds_read_b64_tr_b16 a[170:171], v4 offset:19456
    ds_read_b64_tr_b16 a[172:173], v5 offset:18432
    ds_read_b64_tr_b16 a[174:175], v5 offset:19456
    ds_read_b64_tr_b16 a[176:177], v4 offset:20480
    ds_read_b64_tr_b16 a[178:179], v4 offset:21504
    ds_read_b64_tr_b16 a[180:181], v5 offset:20480
    ds_read_b64_tr_b16 a[182:183], v5 offset:21504
    ds_read_b64_tr_b16 a[184:185], v4 offset:22528
    ds_read_b64_tr_b16 a[186:187], v4 offset:23552
    ds_read_b64_tr_b16 a[188:189], v5 offset:22528
    ds_read_b64_tr_b16 a[190:191], v5 offset:23552
    s_waitcnt vmcnt(12)
    ds_read_b64_tr_b16 a[192:193], v4 offset:0
    ds_read_b64_tr_b16 a[194:195], v4 offset:1024
    ds_read_b64_tr_b16 a[196:197], v5 offset:0
    ds_read_b64_tr_b16 a[198:199], v5 offset:1024
    ds_read_b64_tr_b16 a[200:201], v4 offset:2048
    ds_read_b64_tr_b16 a[202:203], v4 offset:3072
    ds_read_b64_tr_b16 a[204:205], v5 offset:2048
    ds_read_b64_tr_b16 a[206:207], v5 offset:3072
    ds_read_b64_tr_b16 a[208:209], v4 offset:4096
    ds_read_b64_tr_b16 a[210:211], v4 offset:5120
    ds_read_b64_tr_b16 a[212:213], v5 offset:4096
    ds_read_b64_tr_b16 a[214:215], v5 offset:5120
    ds_read_b64_tr_b16 a[216:217], v4 offset:6144
    ds_read_b64_tr_b16 a[218:219], v4 offset:7168
    ds_read_b64_tr_b16 a[220:221], v5 offset:6144
    ds_read_b64_tr_b16 a[222:223], v5 offset:7168
    s_waitcnt lgkmcnt(0)
    s_waitcnt vmcnt(0)
    s_mov_b64 exec, 0x1
    buffer_store_dword v31, v32, s[76:79], s1 offen sc1
    s_mov_b64 exec, -1
    s_add_u32 s40, s19, 262144
    s_add_u32 m0, s14, 2048
    s_nop 0
    buffer_load_dwordx4 v36, s[68:71], s40 offen offset:0 lds
    buffer_load_dwordx4 v37, s[68:71], s40 offen offset:1024 lds
    s_add_u32 s40, s40, 16384
    s_add_u32 m0, s14, 4096
    s_nop 0
    buffer_load_dwordx4 v36, s[68:71], s40 offen offset:0 lds
    buffer_load_dwordx4 v37, s[68:71], s40 offen offset:1024 lds
    s_add_u32 s40, s40, 16384
    s_add_u32 m0, s14, 6144
    s_nop 0
    buffer_load_dwordx4 v36, s[68:71], s40 offen offset:0 lds
    buffer_load_dwordx4 v37, s[68:71], s40 offen offset:1024 lds
    s_add_u32 s40, s40, 16384
    s_add_u32 s40, s19, 376832
    s_add_u32 m0, s14, 16384
    s_nop 0
    buffer_load_dwordx4 v36, s[68:71], s40 offen offset:0 lds
    buffer_load_dwordx4 v37, s[68:71], s40 offen offset:1024 lds
    s_add_u32 s40, s40, 16384
    s_add_u32 m0, s14, 18432
    s_nop 0
    buffer_load_dwordx4 v36, s[68:71], s40 offen offset:0 lds
    buffer_load_dwordx4 v37, s[68:71], s40 offen offset:1024 lds
    s_add_u32 s40, s40, 16384
    s_add_u32 m0, s14, 20480
    s_nop 0
    buffer_load_dwordx4 v36, s[68:71], s40 offen offset:0 lds
    buffer_load_dwordx4 v37, s[68:71], s40 offen offset:1024 lds
    s_add_u32 s40, s40, 16384
    s_add_u32 m0, s14, 22528
    s_nop 0
    buffer_load_dwordx4 v36, s[68:71], s40 offen offset:0 lds
    buffer_load_dwordx4 v37, s[68:71], s40 offen offset:1024 lds
    s_add_u32 s40, s40, 16384
    s_add_u32 s40, s19, 442368
    s_add_u32 m0, s14, 0
    s_nop 0
    buffer_load_dwordx4 v36, s[68:71], s40 offen offset:0 lds
    buffer_load_dwordx4 v37, s[68:71], s40 offen offset:1024 lds
    s_add_u32 s40, s40, 16384
    s_xor_b32 s10, s41, 224
    s_or_b32 s10, s10, s3
    s_cmp_lg_u32 s10, 0
    s_cbranch_scc1 L_noep
    v_and_b32 v64, 31, v0
    v_lshrrev_b32 v65, 5, v0
    v_lshlrev_b32 v64, 7, v64
    v_lshl_add_u32 v64, v65, 14, v64
    s_mov_b32 s4, 12976128
    s_mov_b32 s5, 13008896
    s_mov_b32 s6, 13041664
    s_mov_b32 s7, 13074432
    s_mov_b32 s16, 0x8000
L_ep:
    buffer_load_dword v66, v64, s[76:79], s4 offen sc1
    buffer_load_dword v67, v64, s[76:79], s5 offen sc1
    buffer_load_dword v68, v64, s[76:79], s6 offen sc1
    buffer_load_dword v69, v64, s[76:79], s7 offen sc1
    s_waitcnt vmcnt(0)
    v_xor_b32 v66, s12, v66
    v_xor_b32 v67, s12, v67
    v_xor_b32 v68, s12, v68
    v_xor_b32 v69, s12, v69
    v_or_b32 v66, v66, v67
    v_or3_b32 v66, v66, v68, v69
    v_cmp_ne_u32 vcc, 0, v66
    s_sub_u32 s16, s16, 1
    s_cbranch_scc1 L_epw
    s_cbranch_vccnz L_ep
L_epw:
    s_mov_b32 s10, 12857344
    buffer_store_dword v31, v32, s[76:79], s10 offen sc1
L_noep:
    v_mov_b32 v30, s12
    s_mov_b64 exec, 0xf
    buffer_load_dword v30, v28, s[76:79], 0 offen sc1
    s_mov_b64 exec, -1
    s_waitcnt vmcnt(0)
    v_cmp_ne_u32 vcc, s12, v30
    s_nop 1
    s_cbranch_vccnz L_slow5
L_back5:
    s_add_u32 s11, s29, 32768
    buffer_load_dwordx4 a[240:243], v29, s[44:47], s29 offen
    buffer_load_dwordx4 a[244:247], v29, s[44:47], s11 offen
    v_lshrrev_b32 v28, 3, v0
    v_lshlrev_b32 v28, 4, v28
    buffer_load_dwordx4 a[248:251], v28, s[76:79], s30 offen sc1
    buffer_load_dwordx4 a[252:255], v28, s[76:79], s30 offen offset:512 sc1
    v_mov_b32 v34, s12
    s_mov_b64 exec, 0xff
    buffer_load_dword v34, v35, s[76:79], s86 offen sc1
    s_mov_b64 exec, -1
    s_waitcnt vmcnt(0)
    v_cmp_ne_u32 vcc, s12, v34
    s_nop 1
    s_cbranch_vccnz L_slow6
L_back6:
    s_branch L_g2
L_slow0:
    s_mov_b32 s16, 0x8000
L_spin0:
    buffer_load_dword v126, v127, s[76:79], 0 offen sc1
    s_waitcnt vmcnt(0)
    v_cmp_ne_u32 vcc, s12, v126
    s_sub_u32 s16, s16, 1
    s_cbranch_scc1 L_back0
    s_nop 1
    s_cbranch_vccz L_back0
    s_sleep 3
    s_branch L_spin0
L_slow1:
    s_mov_b32 s16, 0x8000
L_spin1:
    buffer_load_dword v34, v35, s[76:79], s85 offen sc1
    s_waitcnt vmcnt(0)
    v_cmp_ne_u32 vcc, s12, v34
    s_sub_u32 s16, s16, 1
    s_cbranch_scc1 L_back1
    s_nop 1
    s_cbranch_vccz L_back1
    s_sleep 3
    s_branch L_spin1
L_slow2:
    s_mov_b32 s16, 0x8000
L_spin2:
    buffer_load_dword v34, v35, s[76:79], s85 offen sc1
    s_waitcnt vmcnt(0)
    v_cmp_ne_u32 vcc, s12, v34
    s_sub_u32 s16, s16, 1
    s_cbranch_scc1 L_back2
    s_nop 1
    s_cbranch_vccz L_back2
    s_sleep 3
    s_branch L_spin2
L_slow3:
    s_mov_b32 s16, 0x8000
L_spin3:
    buffer_load_dword v30, v28, s[76:79], 0 offen sc1
    s_waitcnt vmcnt(0)
    v_cmp_ne_u32 vcc, s12, v30
    s_sub_u32 s16, s16, 1
    s_cbranch_scc1 L_back3
    s_nop 1
    s_cbranch_vccz L_back3
    s_sleep 3
    s_branch L_spin3
L_slow4:
    s_mov_b32 s16, 0x8000
L_spin4:
    buffer_load_dword v34, v35, s[76:79], s86 offen sc1
    s_waitcnt vmcnt(0)
    v_cmp_ne_u32 vcc, s12, v34
    s_sub_u32 s16, s16, 1
    s_cbranch_scc1 L_back4
    s_nop 1
    s_cbranch_vccz L_back4
    s_sleep 3
    s_branch L_spin4
L_slow5:
    s_mov_b32 s16, 0x8000
L_spin5:
    buffer_load_dword v30, v28, s[76:79], 0 offen sc1
    s_waitcnt vmcnt(0)
    v_cmp_ne_u32 vcc, s12, v30
    s_sub_u32 s16, s16, 1
    s_cbranch_scc1 L_back5
    s_nop 1
    s_cbranch_vccz L_back5
    s_sleep 3
    s_branch L_spin5
L_slow6:
    s_mov_b32 s16, 0x8000
L_spin6:
    buffer_load_dword v34, v35, s[76:79], s86 offen sc1
    s_waitcnt vmcnt(0)
    v_cmp_ne_u32 vcc, s12, v34
    s_sub_u32 s16, s16, 1
    s_cbranch_scc1 L_back6
    s_nop 1
    s_cbranch_vccz L_back6
    s_sleep 3
    s_branch L_spin6
L_slow7:
    s_mov_b32 s16, 0x8000
L_spin7:
    buffer_load_dword v34, v35, s[76:79], s87 offen sc1
    s_waitcnt vmcnt(0)
    v_cmp_ne_u32 vcc, s12, v34
    s_sub_u32 s16, s16, 1
    s_cbranch_scc1 L_back7
    s_nop 1
    s_cbranch_vccz L_back7
    s_sleep 3
    s_branch L_spin7
.section .rodata,"a"
.p2align 6
.amdhsa_kernel parallel_sum__ssm_conv_h3__glu_gated_reglu__prompt_kernel
  .amdhsa_next_free_vgpr 512
  .amdhsa_next_free_sgpr 102
  .amdhsa_accum_offset 256
  .amdhsa_group_segment_fixed_size 0
  .amdhsa_kernarg_size 104
  .amdhsa_user_sgpr_count 2
  .amdhsa_user_sgpr_kernarg_segment_ptr 1
  .amdhsa_system_sgpr_workgroup_id_x 1
  .amdhsa_float_denorm_mode_32 3
  .amdhsa_float_denorm_mode_16_64 3
.end_amdhsa_kernel
```
